```python
import torch

def _softmax(x, axis=-1):
    return torch.softmax(x, dim=axis)
def _gelu(x):
    return torch.nn.functional.gelu(x, approximate="tanh")
def _silu(x):
    return torch.nn.functional.silu(x)
def _sigmoid(x):
    return torch.sigmoid(x)
def _layernorm(x, axis=-1, eps=1e-5):
    m = x.mean(dim=axis, keepdim=True)
    v = x.var(dim=axis, keepdim=True, unbiased=False)
    return (x - m) / torch.sqrt(v + eps)
def _scatter_add(tgt, idx, src, axis=0):
    return tgt.clone().index_add_(axis, idx, src)
def _segment_sum(src, seg, n):
    out = torch.zeros((n,) + src.shape[1:], dtype=src.dtype)
    return out.index_add_(0, seg, src)
def _pad(x, pw):
    flat = tuple(v for pair in reversed(pw) for v in pair)
    return torch.nn.functional.pad(x, flat)

kernel_name = 'recurrent_scan__ssm_conv_s4d__moe_arch_mod__prompt'

def setup_inputs():

    _w = (lambda a: (lambda t: t.to(torch.bfloat16) if t.is_floating_point() else t)(torch.as_tensor(a)))
    def _A_setup():
        Bsz, L, D, N = 1, 2048, 448, 256
        return {
            "u": _w((lambda *s: torch.randn(*s, dtype=torch.bfloat16) * 0.05)(Bsz, L, D)),
            "log_A_real": _w((lambda *s: torch.randn(*s, dtype=torch.bfloat16) * 6.4)(D, N) * 0.5),
            "A_imag": _w((lambda *s: torch.randn(*s, dtype=torch.bfloat16) * 0.05)(D, N) * 3.14),
            "C_real": _w((lambda *s: torch.randn(*s, dtype=torch.bfloat16) * 0.05)(D, N) / N ** 0.5),
            "C_imag": _w((lambda *s: torch.randn(*s, dtype=torch.bfloat16) * 0.05)(D, N) / N ** 0.5),
            "log_dt": _w((lambda *s: torch.randn(*s, dtype=torch.bfloat16) * 0.05)(D) * 0.5 - 4.0),
            "D_skip": _w((lambda *s: torch.randn(*s, dtype=torch.bfloat16) * 0.05)(D)),
        }
    _A_in = _A_setup()

    def _B_setup():
        B, S, D, F, C = 1, 2048, 448, 1792, 2
        return {
            "x": _w((lambda *s: torch.randn(*s, dtype=torch.bfloat16) * 0.05)(B, S, D)),
            "w_r": _w((lambda *s: torch.randn(*s, dtype=torch.bfloat16) * 6.4)(D)),
            "w_gate": _w((lambda *s: torch.randn(*s, dtype=torch.bfloat16) * 0.1)(D, F)),
            "w_up": _w((lambda *s: torch.randn(*s, dtype=torch.bfloat16) * 0.1)(D, F)),
            "w_down": _w((lambda *s: torch.randn(*s, dtype=torch.bfloat16) * 0.1)(F, D)),
        }
    _B_in = _B_setup()

    return {
        "A_u": _A_in["u"],
        "A_log_A_real": _A_in["log_A_real"],
        "A_A_imag": _A_in["A_imag"],
        "A_C_real": _A_in["C_real"],
        "A_C_imag": _A_in["C_imag"],
        "A_log_dt": _A_in["log_dt"],
        "A_D_skip": _A_in["D_skip"],
        "B_x": _B_in["x"],
        "B_w_r": _B_in["w_r"],
        "B_w_gate": _B_in["w_gate"],
        "B_w_up": _B_in["w_up"],
        "B_w_down": _B_in["w_down"],
    }

def reference(A_u, A_log_A_real, A_A_imag, A_C_real, A_C_imag, A_log_dt, A_D_skip, B_x, B_w_r, B_w_gate, B_w_up, B_w_down):
    def _A_ref(u, log_A_real, A_imag, C_real, C_imag, log_dt, D_skip):
        L = u.shape[1]
        dt = torch.exp(log_dt)
        A = -torch.exp(log_A_real) + 1j * A_imag
        C = (C_real + 1j * C_imag) * dt[:, None]
        pos = (lambda x, dt: x.to(dt))(torch.arange(L), log_dt.dtype)
        P = torch.exp((A * dt[:, None])[:, :, None] * pos[None, None, :])
        K = 2.0 * torch.einsum("dn,dnl->dl", C, P).real
        L2 = 2 * L
        u_t = (lambda x, *d: x.permute(*d))(u, 0, 2, 1)
        Kf = (lambda x, *a, **k: torch.fft.rfft(x.float(), *a, **k))(K, L2)
        Uf = (lambda x, *a, **k: torch.fft.rfft(x.float(), *a, **k))(u_t, L2)
        y = (lambda x, *a, **k: torch.fft.irfft(x, *a, **k).to(torch.bfloat16))(Uf * Kf[None, :, :], L2)[:, :, :L]
        y = (lambda x, *d: x.permute(*d))(y, 0, 2, 1)
        return y + u * D_skip[None, None, :]

    def _B_ref(x, w_r, w_gate, w_up, w_down):
        B, S, D = x.shape
        C = 2
        r = x @ w_r
        idx = torch.argsort(-r, axis=-1)[:, :C]
        idx_e = (lambda x, n, axis: torch.repeat_interleave(x, n, dim=axis))(idx.reshape(B, C, 1), D, axis=2)
        x_sel = (lambda x, i, axis: torch.take_along_dim(x, i, dim=axis))(x, idx_e, axis=1)
        g = _silu(x_sel @ w_gate)
        u = x_sel @ w_up
        y = (g * u) @ w_down
        r_sel = _sigmoid((lambda x, i, axis: torch.take_along_dim(x, i, dim=axis))(r, idx, axis=1))
        y = y * r_sel.reshape(B, C, 1)
        b_off = (torch.arange(B) * S).reshape(B, 1)
        flat_idx = (idx + b_off).reshape(B * C)
        zero = (x * 0.0).reshape(B * S, D)
        upd = _scatter_add(zero, flat_idx, y.reshape(B * C, D), axis=0)
        return x + upd.reshape(B, S, D)

    x = A_u
    xn = _layernorm(x, axis=-1)
    s = _A_ref(xn, A_log_A_real, A_A_imag, A_C_real, A_C_imag, A_log_dt, A_D_skip)
    g = _silu(_B_ref(xn, B_w_r, B_w_gate, B_w_up, B_w_down))
    return x + s * g
```

```asm
; @launch grid=(256,1,1) block=(512,1,1) lds=128000
.amdgcn_target "amdgcn-amd-amdhsa--gfx950"
.text
.globl recurrent_scan__ssm_conv_s4d__moe_arch_mod__prompt_kernel
.p2align 8
.type recurrent_scan__ssm_conv_s4d__moe_arch_mod__prompt_kernel,@function
recurrent_scan__ssm_conv_s4d__moe_arch_mod__prompt_kernel:
    s_cmp_ge_u32 s2, 256
    s_cbranch_scc1 L_end
    s_load_dwordx2 s[4:5], s[0:1], 0
    s_load_dwordx2 s[6:7], s[0:1], 64
    s_load_dwordx2 s[8:9], s[0:1], 112
    s_load_dwordx2 s[10:11], s[0:1], 96
    s_load_dwordx8 s[12:19], s[0:1], 8
    s_load_dwordx4 s[20:23], s[0:1], 40
    s_load_dwordx4 s[24:27], s[0:1], 72
    s_load_dwordx2 s[28:29], s[0:1], 88
    v_and_b32 v1, 63, v0
    v_lshrrev_b32 v2, 6, v0
    s_lshr_b32 s51, s2, 3
    v_readfirstlane_b32 s30, v2
    v_lshlrev_b32 v76, 4, v1
    s_lshr_b32 s33, s30, 1
    s_lshl_b32 s33, s33, 10
    s_lshl_b32 s34, s2, 1
    s_add_u32 s33, s33, s34
    s_and_b32 s34, s30, 1
    s_add_u32 s33, s33, s34
    s_mul_i32 s49, s33, 896
    v_mov_b32 v64, 0
    v_mov_b32 v65, 0
    v_mov_b32 v66, 0
    v_mov_b32 v67, 0
    v_mov_b32 v68, 0
    v_mov_b32 v69, 0
    v_mov_b32 v70, 0
    v_mov_b32 v71, 0
    v_mov_b32 v72, 0
    v_mov_b32 v73, 0
    v_mov_b32 v74, 0
    v_mov_b32 v75, 0
    s_cmp_ge_u32 s51, 28
    s_cbranch_scc1 L_ffn
    s_and_b32 s34, s2, 7
    s_mul_i32 s34, s34, 28
    s_add_u32 s32, s34, s51
    s_lshr_b32 s37, s30, 2
    s_waitcnt lgkmcnt(0)
    s_load_dword s31, s[8:9], 0
    s_cmp_ge_u32 s30, 4
    s_cbranch_scc1 L_c_noln
    s_add_u32 s38, s4, s49
    s_addc_u32 s39, s5, 0
    s_mov_b32 exec_hi, 0x00ffffff
    global_load_dwordx4 v[64:67], v76, s[38:39]
    s_add_u32 s40, s38, 458752
    s_addc_u32 s41, s39, 0
    global_load_dwordx4 v[68:71], v76, s[40:41]
    global_load_dwordx4 v[72:75], v76, s[6:7]
    s_mov_b32 exec_hi, -1
    v_and_b32 v10, 255, v0
    v_lshlrev_b32 v10, 1, v10
    s_lshl_b32 s33, s32, 1
    s_add_u32 s33, s33, s37
    s_lshl_b32 s33, s33, 9
    s_add_u32 s12, s12, s33
    s_addc_u32 s13, s13, 0
    s_add_u32 s14, s14, s33
    s_addc_u32 s15, s15, 0
    s_add_u32 s16, s16, s33
    s_addc_u32 s17, s17, 0
    s_add_u32 s18, s18, s33
    s_addc_u32 s19, s19, 0
    v_mov_b32 v124, 0
    v_mov_b32 v125, 0
    v_mov_b32 v126, 0
    v_mov_b32 v127, 0
    global_load_short_d16_hi v124, v10, s[12:13]
    global_load_short_d16_hi v125, v10, s[14:15]
    global_load_short_d16_hi v126, v10, s[16:17]
    global_load_short_d16_hi v127, v10, s[18:19]
    v_lshlrev_b32 v10, 3, v1
    global_load_dwordx2 v[56:57], v10, s[16:17]
    global_load_dwordx2 v[58:59], v10, s[18:19]
    s_lshl_b32 s33, s32, 2
    s_add_u32 s20, s20, s33
    s_addc_u32 s21, s21, 0
    s_add_u32 s22, s22, s33
    s_addc_u32 s23, s23, 0
    s_load_dword s44, s[20:21], 0
    s_load_dword s45, s[22:23], 0
    s_getpc_b64 s[40:41]
    s_add_u32 s40, s40, T1_table@rel32@lo+4
    s_addc_u32 s41, s41, T1_table@rel32@hi+12
    v_mul_u32_u24 v10, 48, v0
    global_load_dwordx4 v[112:115], v10, s[40:41] offset:0
    global_load_dwordx4 v[116:119], v10, s[40:41] offset:16
    global_load_dwordx4 v[120:123], v10, s[40:41] offset:32
    v_mov_b32 v111, v0
    v_mul_u32_u24 v2, 896, v111
    s_lshl_b32 s33, s32, 2
    v_add_u32 v2, s33, v2
    s_add_u32 s60, s4, 458752
    s_addc_u32 s61, s5, 0
    s_add_u32 s62, s10, 458752
    s_addc_u32 s63, s11, 0
    s_add_u32 s42, s4, 917504
    s_addc_u32 s43, s5, 0
    s_add_u32 s98, s10, 917504
    s_addc_u32 s99, s11, 0
    s_add_u32 s96, s4, 1376256
    s_addc_u32 s97, s5, 0
    s_add_u32 s100, s10, 1376256
    s_addc_u32 s101, s11, 0
    v_mov_b32 v10, 0
    v_mov_b32 v11, 0
    v_mov_b32 v12, 0
    v_mov_b32 v13, 0
    v_bfe_u32 v14, v0, 5, 1
    v_mul_u32_u24 v14, 4608, v14
    v_and_b32 v15, 31, v0
    v_lshl_add_u32 v14, v15, 4, v14
    v_add_u32 v14, 118464, v14
    ds_write_b128 v14, v[10:13]
    v_and_b32 v14, 1, v0
    v_mul_u32_u24 v14, 1536, v14
    v_add_u32 v14, 116840, v14
    ds_write_b64 v14, v[10:11]
    s_waitcnt lgkmcnt(0)
    s_lshl_b32 s33, s44, 16
    s_and_b32 s34, s44, 0xffff0000
    s_cmp_eq_u32 s37, 0
    s_cselect_b32 s52, s33, s34
    v_mov_b32 v22, 0x3fb8aa3b
    v_mov_b32 v23, 0x32a57060
    v_mul_f32 v80, s52, v22
    v_fma_f32 v82, s52, v22, -v80
    v_exp_f32 v80, v80
    v_fma_f32 v82, s52, v23, v82
    v_mul_f32 v82, 0x3f317218, v82
    v_fma_f32 v80, v80, v82, v80
    v_cvt_pk_bf16_f32 v84, v80, v80
    v_lshlrev_b32 v18, 16, v84
    v_mul_f32 v19, 0xbfb8aa3b, v18
    v_mul_f32 v20, 0x3e22f983, v18
    v_add_f32 v21, v18, v18
    s_mul_i32 s48, s30, 14416
    v_and_b32 v80, 31, v1
    v_lshrrev_b32 v81, 5, v1
    v_mul_u32_u24 v96, 272, v80
    v_lshl_add_u32 v96, v81, 4, v96
    v_add_u32 v96, s48, v96
    v_min_u32 v82, 20, v80
    v_mul_u32_u24 v97, 272, v82
    v_lshl_add_u32 v97, v81, 4, v97
    v_add_u32 v97, s48, v97
    v_add_u32 v97, 8704, v97
    v_mul_u32_u24 v98, 144, v80
    v_lshl_add_u32 v98, v81, 4, v98
    v_add_u32 v98, s48, v98
    v_mov_b32 v52, 0x3b124925
    v_cmp_gt_u32 vcc, 56, v1
    s_nop 1
    v_cndmask_b32 v50, 0, 1.0, vcc
    v_mov_b32 v51, v50
    s_lshr_b32 s33, s30, 1
    s_lshl_b32 s33, s33, 13
    s_lshl_b32 s34, s2, 5
    s_add_u32 s33, s33, s34
    s_and_b32 s34, s30, 1
    s_lshl_b32 s34, s34, 4
    s_add_u32 s33, s33, s34
    s_add_u32 s33, s33, 4096
    v_mov_b32 v53, s33
    s_waitcnt vmcnt(9) lgkmcnt(0)
    s_add_u32 s31, s31, 0x9e3779b9
    v_lshlrev_b32 v10, 16, v72
    v_and_b32 v11, 0xffff0000, v72
    v_lshlrev_b32 v12, 16, v73
    v_and_b32 v13, 0xffff0000, v73
    v_lshlrev_b32 v14, 16, v74
    v_and_b32 v15, 0xffff0000, v74
    v_lshlrev_b32 v16, 16, v75
    v_and_b32 v17, 0xffff0000, v75
    v_lshlrev_b32 v24, 16, v64
    v_lshlrev_b32 v25, 16, v68
    v_and_b32 v26, 0xffff0000, v64
    v_and_b32 v27, 0xffff0000, v68
    v_lshlrev_b32 v28, 16, v65
    v_lshlrev_b32 v29, 16, v69
    v_and_b32 v30, 0xffff0000, v65
    v_and_b32 v31, 0xffff0000, v69
    v_lshlrev_b32 v32, 16, v66
    v_lshlrev_b32 v33, 16, v70
    v_and_b32 v34, 0xffff0000, v66
    v_and_b32 v35, 0xffff0000, v70
    v_lshlrev_b32 v36, 16, v67
    v_lshlrev_b32 v37, 16, v71
    v_and_b32 v38, 0xffff0000, v67
    v_and_b32 v39, 0xffff0000, v71
    v_pk_add_f32 v[40:41], v[24:25], v[26:27]
    v_pk_mul_f32 v[42:43], v[24:25], v[10:11] op_sel:[0,0] op_sel_hi:[1,0]
    v_pk_add_f32 v[44:45], v[10:11], v[12:13]
    v_pk_fma_f32 v[42:43], v[10:11], v[26:27], v[42:43] op_sel:[1,0,0] op_sel_hi:[1,1,1]
    v_pk_add_f32 v[40:41], v[40:41], v[28:29]
    v_pk_fma_f32 v[42:43], v[28:29], v[12:13], v[42:43] op_sel:[0,0,0] op_sel_hi:[1,0,1]
    v_pk_add_f32 v[40:41], v[40:41], v[30:31]
    v_pk_fma_f32 v[42:43], v[12:13], v[30:31], v[42:43] op_sel:[1,0,0] op_sel_hi:[1,1,1]
    v_pk_add_f32 v[40:41], v[40:41], v[32:33]
    v_pk_fma_f32 v[42:43], v[32:33], v[14:15], v[42:43] op_sel:[0,0,0] op_sel_hi:[1,0,1]
    v_pk_add_f32 v[40:41], v[40:41], v[34:35]
    v_pk_fma_f32 v[42:43], v[14:15], v[34:35], v[42:43] op_sel:[1,0,0] op_sel_hi:[1,1,1]
    v_pk_add_f32 v[40:41], v[40:41], v[36:37]
    v_pk_fma_f32 v[42:43], v[36:37], v[16:17], v[42:43] op_sel:[0,0,0] op_sel_hi:[1,0,1]
    v_pk_add_f32 v[40:41], v[40:41], v[38:39]
    v_pk_fma_f32 v[42:43], v[16:17], v[38:39], v[42:43] op_sel:[1,0,0] op_sel_hi:[1,1,1]
    v_pk_add_f32 v[44:45], v[44:45], v[14:15]
    v_pk_add_f32 v[44:45], v[44:45], v[16:17]
    v_add_f32 v44, v44, v45
    v_add_f32_dpp v40, v40, v40 row_shr:1 row_mask:0xf bank_mask:0xf bound_ctrl:0
    v_add_f32_dpp v41, v41, v41 row_shr:1 row_mask:0xf bank_mask:0xf bound_ctrl:0
    v_add_f32_dpp v42, v42, v42 row_shr:1 row_mask:0xf bank_mask:0xf bound_ctrl:0
    v_add_f32_dpp v43, v43, v43 row_shr:1 row_mask:0xf bank_mask:0xf bound_ctrl:0
    v_add_f32_dpp v44, v44, v44 row_shr:1 row_mask:0xf bank_mask:0xf bound_ctrl:0
    v_add_f32_dpp v40, v40, v40 row_shr:2 row_mask:0xf bank_mask:0xf bound_ctrl:0
    v_add_f32_dpp v41, v41, v41 row_shr:2 row_mask:0xf bank_mask:0xf bound_ctrl:0
    v_add_f32_dpp v42, v42, v42 row_shr:2 row_mask:0xf bank_mask:0xf bound_ctrl:0
    v_add_f32_dpp v43, v43, v43 row_shr:2 row_mask:0xf bank_mask:0xf bound_ctrl:0
    v_add_f32_dpp v44, v44, v44 row_shr:2 row_mask:0xf bank_mask:0xf bound_ctrl:0
    v_add_f32_dpp v40, v40, v40 row_shr:4 row_mask:0xf bank_mask:0xf bound_ctrl:0
    v_add_f32_dpp v41, v41, v41 row_shr:4 row_mask:0xf bank_mask:0xf bound_ctrl:0
    v_add_f32_dpp v42, v42, v42 row_shr:4 row_mask:0xf bank_mask:0xf bound_ctrl:0
    v_add_f32_dpp v43, v43, v43 row_shr:4 row_mask:0xf bank_mask:0xf bound_ctrl:0
    v_add_f32_dpp v44, v44, v44 row_shr:4 row_mask:0xf bank_mask:0xf bound_ctrl:0
    v_add_f32_dpp v40, v40, v40 row_shr:8 row_mask:0xf bank_mask:0xf bound_ctrl:0
    v_add_f32_dpp v41, v41, v41 row_shr:8 row_mask:0xf bank_mask:0xf bound_ctrl:0
    v_add_f32_dpp v42, v42, v42 row_shr:8 row_mask:0xf bank_mask:0xf bound_ctrl:0
    v_add_f32_dpp v43, v43, v43 row_shr:8 row_mask:0xf bank_mask:0xf bound_ctrl:0
    v_add_f32_dpp v44, v44, v44 row_shr:8 row_mask:0xf bank_mask:0xf bound_ctrl:0
    v_add_f32_dpp v40, v40, v40 row_bcast:15 row_mask:0xa bank_mask:0xf
    v_add_f32_dpp v41, v41, v41 row_bcast:15 row_mask:0xa bank_mask:0xf
    v_add_f32_dpp v42, v42, v42 row_bcast:15 row_mask:0xa bank_mask:0xf
    v_add_f32_dpp v43, v43, v43 row_bcast:15 row_mask:0xa bank_mask:0xf
    v_add_f32_dpp v44, v44, v44 row_bcast:15 row_mask:0xa bank_mask:0xf
    v_add_f32_dpp v40, v40, v40 row_bcast:31 row_mask:0xc bank_mask:0xf
    v_add_f32_dpp v41, v41, v41 row_bcast:31 row_mask:0xc bank_mask:0xf
    v_add_f32_dpp v42, v42, v42 row_bcast:31 row_mask:0xc bank_mask:0xf
    v_add_f32_dpp v43, v43, v43 row_bcast:31 row_mask:0xc bank_mask:0xf
    v_add_f32_dpp v44, v44, v44 row_bcast:31 row_mask:0xc bank_mask:0xf
    v_readlane_b32 s52, v40, 63
    v_readlane_b32 s53, v41, 63
    s_nop 0
    v_mul_f32 v46, s52, v52
    v_mul_f32 v47, s53, v52
    v_pk_add_f32 v[24:25], v[24:25], v[46:47] neg_lo:[0,1] neg_hi:[0,1]
    v_pk_add_f32 v[26:27], v[26:27], v[46:47] neg_lo:[0,1] neg_hi:[0,1]
    v_pk_add_f32 v[28:29], v[28:29], v[46:47] neg_lo:[0,1] neg_hi:[0,1]
    v_pk_add_f32 v[30:31], v[30:31], v[46:47] neg_lo:[0,1] neg_hi:[0,1]
    v_pk_add_f32 v[32:33], v[32:33], v[46:47] neg_lo:[0,1] neg_hi:[0,1]
    v_pk_add_f32 v[34:35], v[34:35], v[46:47] neg_lo:[0,1] neg_hi:[0,1]
    v_pk_add_f32 v[36:37], v[36:37], v[46:47] neg_lo:[0,1] neg_hi:[0,1]
    v_pk_add_f32 v[38:39], v[38:39], v[46:47] neg_lo:[0,1] neg_hi:[0,1]
    v_pk_mul_f32 v[48:49], v[24:25], v[24:25]
    v_pk_fma_f32 v[48:49], v[26:27], v[26:27], v[48:49]
    v_pk_fma_f32 v[48:49], v[28:29], v[28:29], v[48:49]
    v_pk_fma_f32 v[48:49], v[30:31], v[30:31], v[48:49]
    v_pk_fma_f32 v[48:49], v[32:33], v[32:33], v[48:49]
    v_pk_fma_f32 v[48:49], v[34:35], v[34:35], v[48:49]
    v_pk_fma_f32 v[48:49], v[36:37], v[36:37], v[48:49]
    v_pk_fma_f32 v[48:49], v[38:39], v[38:39], v[48:49]
    v_pk_mul_f32 v[48:49], v[48:49], v[50:51]
    s_nop 1
    v_add_f32_dpp v48, v48, v48 row_shr:1 row_mask:0xf bank_mask:0xf bound_ctrl:0
    v_add_f32_dpp v49, v49, v49 row_shr:1 row_mask:0xf bank_mask:0xf bound_ctrl:0
    s_nop 0
    v_add_f32_dpp v48, v48, v48 row_shr:2 row_mask:0xf bank_mask:0xf bound_ctrl:0
    v_add_f32_dpp v49, v49, v49 row_shr:2 row_mask:0xf bank_mask:0xf bound_ctrl:0
    s_nop 0
    v_add_f32_dpp v48, v48, v48 row_shr:4 row_mask:0xf bank_mask:0xf bound_ctrl:0
    v_add_f32_dpp v49, v49, v49 row_shr:4 row_mask:0xf bank_mask:0xf bound_ctrl:0
    s_nop 0
    v_add_f32_dpp v48, v48, v48 row_shr:8 row_mask:0xf bank_mask:0xf bound_ctrl:0
    v_add_f32_dpp v49, v49, v49 row_shr:8 row_mask:0xf bank_mask:0xf bound_ctrl:0
    s_nop 0
    v_add_f32_dpp v48, v48, v48 row_bcast:15 row_mask:0xa bank_mask:0xf
    v_add_f32_dpp v49, v49, v49 row_bcast:15 row_mask:0xa bank_mask:0xf
    s_nop 0
    v_add_f32_dpp v48, v48, v48 row_bcast:31 row_mask:0xc bank_mask:0xf
    v_add_f32_dpp v49, v49, v49 row_bcast:31 row_mask:0xc bank_mask:0xf
    v_readlane_b32 s54, v48, 63
    v_readlane_b32 s55, v49, 63
    v_cvt_pk_bf16_f32 v82, v46, v47
    v_mul_f32 v80, s54, v52
    v_mul_f32 v81, s55, v52
    v_cvt_pk_bf16_f32 v83, v80, v81
    v_lshlrev_b32 v84, 16, v82
    v_and_b32 v85, 0xffff0000, v82
    v_lshlrev_b32 v80, 16, v83
    v_and_b32 v81, 0xffff0000, v83
    v_add_f32 v80, 0x3727c5ac, v80
    v_add_f32 v81, 0x3727c5ac, v81
    v_cvt_pk_bf16_f32 v83, v80, v81
    v_lshlrev_b32 v80, 16, v83
    v_and_b32 v81, 0xffff0000, v83
    v_sqrt_f32 v80, v80
    v_sqrt_f32 v81, v81
    v_fma_f32 v42, -v84, v44, v42
    v_fma_f32 v43, -v85, v44, v43
    v_cvt_pk_bf16_f32 v83, v80, v81
    s_mov_b32 s33, 0x05040100
    s_mov_b32 s34, 0x07060302
    v_lshlrev_b32 v80, 16, v83
    v_and_b32 v81, 0xffff0000, v83
    v_rcp_f32 v80, v80
    v_rcp_f32 v81, v81
    v_perm_b32 v77, v83, v82, s33
    v_perm_b32 v78, v83, v82, s34
    v_mov_b32 v76, s31
    v_mul_f32 v42, v42, v80
    v_mul_f32 v43, v43, v81
    v_cvt_pk_bf16_f32 v79, v42, v43
    s_mov_b32 exec_lo, 0
    s_mov_b32 exec_hi, 0x80000000
    global_store_dwordx4 v53, v[76:79], s[8:9] sc1
    s_mov_b64 exec, -1
    s_waitcnt vmcnt(4)
    v_mul_f32 v124, v22, v124
    v_lshlrev_b32 v85, 16, v56
    v_and_b32 v86, 0xffff0000, v56
    v_add_f32 v81, |v85|, |v86|
    v_exp_f32 v124, v124
    v_lshlrev_b32 v85, 16, v57
    v_and_b32 v86, 0xffff0000, v57
    v_add_f32 v81, |v85|, v81
    v_add_f32 v81, |v86|, v81
    v_lshlrev_b32 v85, 16, v58
    v_and_b32 v86, 0xffff0000, v58
    v_add_f32 v81, |v85|, v81
    v_add_f32 v81, |v86|, v81
    v_lshlrev_b32 v85, 16, v59
    v_and_b32 v86, 0xffff0000, v59
    v_add_f32 v81, |v85|, v81
    v_add_f32 v81, |v86|, v81
    v_cvt_pk_bf16_f32 v84, v124, v124
    s_nop 0
    v_add_f32_dpp v81, v81, v81 row_shr:1 row_mask:0xf bank_mask:0xf bound_ctrl:0
    s_nop 1
    v_add_f32_dpp v81, v81, v81 row_shr:2 row_mask:0xf bank_mask:0xf bound_ctrl:0
    s_nop 1
    v_add_f32_dpp v81, v81, v81 row_shr:4 row_mask:0xf bank_mask:0xf bound_ctrl:0
    s_nop 1
    v_add_f32_dpp v81, v81, v81 row_shr:8 row_mask:0xf bank_mask:0xf bound_ctrl:0
    s_nop 1
    v_add_f32_dpp v81, v81, v81 row_bcast:15 row_mask:0xa bank_mask:0xf
    s_nop 1
    v_add_f32_dpp v81, v81, v81 row_bcast:31 row_mask:0xc bank_mask:0xf
    v_lshlrev_b32 v124, 16, v84
    v_readlane_b32 s54, v81, 63
    s_nop 1
    v_mul_f32 v91, s54, v21
    v_frexp_exp_i32_f32 v80, v91
    v_sub_u32 v82, 14, v80
    v_subrev_u32 v80, 14, v80
    v_ldexp_f32 v48, v21, v82
    v_ldexp_f32 v92, 1.0, v80
    s_lshl_b32 s33, s37, 2
    s_add_u32 s33, s33, 118400
    v_mov_b32 v85, s33
    s_mov_b64 exec, 1
    ds_write_b32 v85, v92
    s_mov_b64 exec, -1
    v_mul_f32 v42, v124, v19
    v_mul_f32 v43, v125, v20
    v_exp_f32 v44, v42
    v_fract_f32 v45, v43
    v_cos_f32 v46, v45
    v_sin_f32 v47, v45
    s_nop 0
    v_pk_mul_f32 v[24:25], v[46:47], v[44:45] op_sel:[0,0] op_sel_hi:[1,0]
    v_mul_f32 v44, 0x41000000, v42
    v_mul_f32 v45, 0x41000000, v43
    v_exp_f32 v44, v44
    v_fract_f32 v45, v45
    v_cos_f32 v46, v45
    v_sin_f32 v47, v45
    s_nop 0
    v_pk_mul_f32 v[26:27], v[46:47], v[44:45] op_sel:[0,0] op_sel_hi:[1,0]
    v_mul_f32 v44, 0x43800000, v42
    v_mul_f32 v45, 0x43800000, v43
    v_exp_f32 v44, v44
    v_fract_f32 v45, v45
    v_cos_f32 v46, v45
    v_sin_f32 v47, v45
    s_nop 0
    v_pk_mul_f32 v[28:29], v[46:47], v[44:45] op_sel:[0,0] op_sel_hi:[1,0]
    v_pk_mul_f32 v[36:37], v[126:127], v[48:49] op_sel:[0,0] op_sel_hi:[1,0]
    s_mov_b32 m0, s48
    v_mov_b32 v40, 0x00003c00
    ds_write_addtid_b32 v40 offset:0
    v_cvt_pk_f16_f32 v50, v26, v27
    ds_write_addtid_b32 v50 offset:272
    v_pk_mul_f32 v[38:39], v[26:27], v[26:27] op_sel:[0,0] op_sel_hi:[1,0]
    v_pk_fma_f32 v[34:35], v[26:27], v[26:27], v[38:39] op_sel:[1,1,0] op_sel_hi:[0,1,1] neg_lo:[0,1,0]
    v_cvt_pk_f16_f32 v51, v34, v35
    ds_write_addtid_b32 v51 offset:544
    v_pk_mul_f32 v[38:39], v[34:35], v[26:27] op_sel:[0,0] op_sel_hi:[1,0]
    v_pk_fma_f32 v[30:31], v[34:35], v[26:27], v[38:39] op_sel:[1,1,0] op_sel_hi:[0,1,1] neg_lo:[0,1,0]
    v_cvt_pk_f16_f32 v52, v30, v31
    ds_write_addtid_b32 v52 offset:816
    v_pk_mul_f32 v[38:39], v[34:35], v[34:35] op_sel:[0,0] op_sel_hi:[1,0]
    v_pk_fma_f32 v[32:33], v[34:35], v[34:35], v[38:39] op_sel:[1,1,0] op_sel_hi:[0,1,1] neg_lo:[0,1,0]
    v_cvt_pk_f16_f32 v53, v32, v33
    ds_write_addtid_b32 v53 offset:1088
    v_pk_mul_f16 v54, v53, v50 op_sel:[0,0] op_sel_hi:[1,0]
    v_pk_fma_f16 v41, v53, v50, v54 op_sel:[1,1,0] op_sel_hi:[0,1,1] neg_lo:[0,1,0]
    ds_write_addtid_b32 v41 offset:1360
    v_pk_mul_f16 v54, v53, v51 op_sel:[0,0] op_sel_hi:[1,0]
    v_pk_fma_f16 v40, v53, v51, v54 op_sel:[1,1,0] op_sel_hi:[0,1,1] neg_lo:[0,1,0]
    ds_write_addtid_b32 v40 offset:1632
    v_pk_mul_f16 v54, v53, v52 op_sel:[0,0] op_sel_hi:[1,0]
    v_pk_fma_f16 v41, v53, v52, v54 op_sel:[1,1,0] op_sel_hi:[0,1,1] neg_lo:[0,1,0]
    ds_write_addtid_b32 v41 offset:1904
    v_pk_mul_f32 v[38:39], v[32:33], v[32:33] op_sel:[0,0] op_sel_hi:[1,0]
    v_pk_fma_f32 v[34:35], v[32:33], v[32:33], v[38:39] op_sel:[1,1,0] op_sel_hi:[0,1,1] neg_lo:[0,1,0]
    v_cvt_pk_f16_f32 v53, v34, v35
    ds_write_addtid_b32 v53 offset:2176
    v_pk_mul_f16 v54, v53, v50 op_sel:[0,0] op_sel_hi:[1,0]
    v_pk_fma_f16 v40, v53, v50, v54 op_sel:[1,1,0] op_sel_hi:[0,1,1] neg_lo:[0,1,0]
    ds_write_addtid_b32 v40 offset:2448
    v_pk_mul_f16 v54, v53, v51 op_sel:[0,0] op_sel_hi:[1,0]
    v_pk_fma_f16 v41, v53, v51, v54 op_sel:[1,1,0] op_sel_hi:[0,1,1] neg_lo:[0,1,0]
    ds_write_addtid_b32 v41 offset:2720
    v_pk_mul_f16 v54, v53, v52 op_sel:[0,0] op_sel_hi:[1,0]
    v_pk_fma_f16 v40, v53, v52, v54 op_sel:[1,1,0] op_sel_hi:[0,1,1] neg_lo:[0,1,0]
    ds_write_addtid_b32 v40 offset:2992
    v_pk_mul_f32 v[38:39], v[34:35], v[32:33] op_sel:[0,0] op_sel_hi:[1,0]
    v_pk_fma_f32 v[34:35], v[34:35], v[32:33], v[38:39] op_sel:[1,1,0] op_sel_hi:[0,1,1] neg_lo:[0,1,0]
    v_cvt_pk_f16_f32 v53, v34, v35
    ds_write_addtid_b32 v53 offset:3264
    v_pk_mul_f16 v54, v53, v50 op_sel:[0,0] op_sel_hi:[1,0]
    v_pk_fma_f16 v41, v53, v50, v54 op_sel:[1,1,0] op_sel_hi:[0,1,1] neg_lo:[0,1,0]
    ds_write_addtid_b32 v41 offset:3536
    v_pk_mul_f16 v54, v53, v51 op_sel:[0,0] op_sel_hi:[1,0]
    v_pk_fma_f16 v40, v53, v51, v54 op_sel:[1,1,0] op_sel_hi:[0,1,1] neg_lo:[0,1,0]
    ds_write_addtid_b32 v40 offset:3808
    v_pk_mul_f16 v54, v53, v52 op_sel:[0,0] op_sel_hi:[1,0]
    v_pk_fma_f16 v41, v53, v52, v54 op_sel:[1,1,0] op_sel_hi:[0,1,1] neg_lo:[0,1,0]
    ds_write_addtid_b32 v41 offset:4080
    v_pk_mul_f32 v[38:39], v[34:35], v[32:33] op_sel:[0,0] op_sel_hi:[1,0]
    v_pk_fma_f32 v[34:35], v[34:35], v[32:33], v[38:39] op_sel:[1,1,0] op_sel_hi:[0,1,1] neg_lo:[0,1,0]
    v_cvt_pk_f16_f32 v53, v34, v35
    ds_write_addtid_b32 v53 offset:4352
    v_pk_mul_f16 v54, v53, v50 op_sel:[0,0] op_sel_hi:[1,0]
    v_pk_fma_f16 v40, v53, v50, v54 op_sel:[1,1,0] op_sel_hi:[0,1,1] neg_lo:[0,1,0]
    ds_write_addtid_b32 v40 offset:4624
    v_pk_mul_f16 v54, v53, v51 op_sel:[0,0] op_sel_hi:[1,0]
    v_pk_fma_f16 v41, v53, v51, v54 op_sel:[1,1,0] op_sel_hi:[0,1,1] neg_lo:[0,1,0]
    ds_write_addtid_b32 v41 offset:4896
    v_pk_mul_f16 v54, v53, v52 op_sel:[0,0] op_sel_hi:[1,0]
    v_pk_fma_f16 v40, v53, v52, v54 op_sel:[1,1,0] op_sel_hi:[0,1,1] neg_lo:[0,1,0]
    ds_write_addtid_b32 v40 offset:5168
    v_pk_mul_f32 v[38:39], v[34:35], v[32:33] op_sel:[0,0] op_sel_hi:[1,0]
    v_pk_fma_f32 v[34:35], v[34:35], v[32:33], v[38:39] op_sel:[1,1,0] op_sel_hi:[0,1,1] neg_lo:[0,1,0]
    v_cvt_pk_f16_f32 v53, v34, v35
    ds_write_addtid_b32 v53 offset:5440
    v_pk_mul_f16 v54, v53, v50 op_sel:[0,0] op_sel_hi:[1,0]
    v_pk_fma_f16 v41, v53, v50, v54 op_sel:[1,1,0] op_sel_hi:[0,1,1] neg_lo:[0,1,0]
    ds_write_addtid_b32 v41 offset:5712
    v_pk_mul_f16 v54, v53, v51 op_sel:[0,0] op_sel_hi:[1,0]
    v_pk_fma_f16 v40, v53, v51, v54 op_sel:[1,1,0] op_sel_hi:[0,1,1] neg_lo:[0,1,0]
    ds_write_addtid_b32 v40 offset:5984
    v_pk_mul_f16 v54, v53, v52 op_sel:[0,0] op_sel_hi:[1,0]
    v_pk_fma_f16 v41, v53, v52, v54 op_sel:[1,1,0] op_sel_hi:[0,1,1] neg_lo:[0,1,0]
    ds_write_addtid_b32 v41 offset:6256
    v_pk_mul_f32 v[38:39], v[34:35], v[32:33] op_sel:[0,0] op_sel_hi:[1,0]
    v_pk_fma_f32 v[34:35], v[34:35], v[32:33], v[38:39] op_sel:[1,1,0] op_sel_hi:[0,1,1] neg_lo:[0,1,0]
    v_cvt_pk_f16_f32 v53, v34, v35
    ds_write_addtid_b32 v53 offset:6528
    v_pk_mul_f16 v54, v53, v50 op_sel:[0,0] op_sel_hi:[1,0]
    v_pk_fma_f16 v40, v53, v50, v54 op_sel:[1,1,0] op_sel_hi:[0,1,1] neg_lo:[0,1,0]
    ds_write_addtid_b32 v40 offset:6800
    v_pk_mul_f16 v54, v53, v51 op_sel:[0,0] op_sel_hi:[1,0]
    v_pk_fma_f16 v41, v53, v51, v54 op_sel:[1,1,0] op_sel_hi:[0,1,1] neg_lo:[0,1,0]
    ds_write_addtid_b32 v41 offset:7072
    v_pk_mul_f16 v54, v53, v52 op_sel:[0,0] op_sel_hi:[1,0]
    v_pk_fma_f16 v40, v53, v52, v54 op_sel:[1,1,0] op_sel_hi:[0,1,1] neg_lo:[0,1,0]
    ds_write_addtid_b32 v40 offset:7344
    v_pk_mul_f32 v[38:39], v[34:35], v[32:33] op_sel:[0,0] op_sel_hi:[1,0]
    v_pk_fma_f32 v[34:35], v[34:35], v[32:33], v[38:39] op_sel:[1,1,0] op_sel_hi:[0,1,1] neg_lo:[0,1,0]
    v_cvt_pk_f16_f32 v53, v34, v35
    ds_write_addtid_b32 v53 offset:7616
    v_pk_mul_f16 v54, v53, v50 op_sel:[0,0] op_sel_hi:[1,0]
    v_pk_fma_f16 v41, v53, v50, v54 op_sel:[1,1,0] op_sel_hi:[0,1,1] neg_lo:[0,1,0]
    ds_write_addtid_b32 v41 offset:7888
    v_pk_mul_f16 v54, v53, v51 op_sel:[0,0] op_sel_hi:[1,0]
    v_pk_fma_f16 v40, v53, v51, v54 op_sel:[1,1,0] op_sel_hi:[0,1,1] neg_lo:[0,1,0]
    ds_write_addtid_b32 v40 offset:8160
    v_pk_mul_f16 v54, v53, v52 op_sel:[0,0] op_sel_hi:[1,0]
    v_pk_fma_f16 v41, v53, v52, v54 op_sel:[1,1,0] op_sel_hi:[0,1,1] neg_lo:[0,1,0]
    ds_write_addtid_b32 v41 offset:8432
    v_cvt_pk_f16_f32 v40, v36, -v37
    ds_write_addtid_b32 v40 offset:8704
    v_pk_mul_f32 v[38:39], v[36:37], v[24:25] op_sel:[0,0] op_sel_hi:[1,0]
    v_pk_fma_f32 v[34:35], v[36:37], v[24:25], v[38:39] op_sel:[1,1,0] op_sel_hi:[0,1,1] neg_lo:[0,1,0]
    v_cvt_pk_f16_f32 v41, v34, -v35
    ds_write_addtid_b32 v41 offset:8976
    v_pk_mul_f32 v[38:39], v[34:35], v[24:25] op_sel:[0,0] op_sel_hi:[1,0]
    v_pk_fma_f32 v[34:35], v[34:35], v[24:25], v[38:39] op_sel:[1,1,0] op_sel_hi:[0,1,1] neg_lo:[0,1,0]
    v_cvt_pk_f16_f32 v40, v34, -v35
    ds_write_addtid_b32 v40 offset:9248
    v_pk_mul_f32 v[38:39], v[34:35], v[24:25] op_sel:[0,0] op_sel_hi:[1,0]
    v_pk_fma_f32 v[34:35], v[34:35], v[24:25], v[38:39] op_sel:[1,1,0] op_sel_hi:[0,1,1] neg_lo:[0,1,0]
    v_cvt_pk_f16_f32 v41, v34, -v35
    ds_write_addtid_b32 v41 offset:9520
    v_pk_mul_f32 v[38:39], v[34:35], v[24:25] op_sel:[0,0] op_sel_hi:[1,0]
    v_pk_fma_f32 v[34:35], v[34:35], v[24:25], v[38:39] op_sel:[1,1,0] op_sel_hi:[0,1,1] neg_lo:[0,1,0]
    v_cvt_pk_f16_f32 v40, v34, -v35
    ds_write_addtid_b32 v40 offset:9792
    v_pk_mul_f32 v[38:39], v[34:35], v[24:25] op_sel:[0,0] op_sel_hi:[1,0]
    v_pk_fma_f32 v[34:35], v[34:35], v[24:25], v[38:39] op_sel:[1,1,0] op_sel_hi:[0,1,1] neg_lo:[0,1,0]
    v_cvt_pk_f16_f32 v41, v34, -v35
    ds_write_addtid_b32 v41 offset:10064
    v_pk_mul_f32 v[38:39], v[34:35], v[24:25] op_sel:[0,0] op_sel_hi:[1,0]
    v_pk_fma_f32 v[34:35], v[34:35], v[24:25], v[38:39] op_sel:[1,1,0] op_sel_hi:[0,1,1] neg_lo:[0,1,0]
    v_cvt_pk_f16_f32 v40, v34, -v35
    ds_write_addtid_b32 v40 offset:10336
    v_pk_mul_f32 v[38:39], v[34:35], v[24:25] op_sel:[0,0] op_sel_hi:[1,0]
    v_pk_fma_f32 v[34:35], v[34:35], v[24:25], v[38:39] op_sel:[1,1,0] op_sel_hi:[0,1,1] neg_lo:[0,1,0]
    v_cvt_pk_f16_f32 v41, v34, -v35
    ds_write_addtid_b32 v41 offset:10608
    v_pk_mul_f32 v[38:39], v[24:25], v[24:25] op_sel:[0,0] op_sel_hi:[1,0]
    v_pk_fma_f32 v[30:31], v[24:25], v[24:25], v[38:39] op_sel:[1,1,0] op_sel_hi:[0,1,1] neg_lo:[0,1,0]
    v_pk_mul_f32 v[38:39], v[30:31], v[30:31] op_sel:[0,0] op_sel_hi:[1,0]
    v_pk_fma_f32 v[32:33], v[30:31], v[30:31], v[38:39] op_sel:[1,1,0] op_sel_hi:[0,1,1] neg_lo:[0,1,0]
    v_pk_mul_f32 v[38:39], v[36:37], v[28:29] op_sel:[0,0] op_sel_hi:[1,0]
    v_pk_fma_f32 v[36:37], v[36:37], v[28:29], v[38:39] op_sel:[1,1,0] op_sel_hi:[0,1,1] neg_lo:[0,1,0]
    v_cvt_pk_f16_f32 v40, v36, -v37
    ds_write_addtid_b32 v40 offset:10880
    v_pk_mul_f32 v[38:39], v[36:37], v[30:31] op_sel:[0,0] op_sel_hi:[1,0]
    v_pk_fma_f32 v[34:35], v[36:37], v[30:31], v[38:39] op_sel:[1,1,0] op_sel_hi:[0,1,1] neg_lo:[0,1,0]
    v_cvt_pk_f16_f32 v41, v34, -v35
    ds_write_addtid_b32 v41 offset:11152
    v_pk_mul_f32 v[38:39], v[34:35], v[30:31] op_sel:[0,0] op_sel_hi:[1,0]
    v_pk_fma_f32 v[34:35], v[34:35], v[30:31], v[38:39] op_sel:[1,1,0] op_sel_hi:[0,1,1] neg_lo:[0,1,0]
    v_cvt_pk_f16_f32 v40, v34, -v35
    ds_write_addtid_b32 v40 offset:11424
    v_pk_mul_f32 v[38:39], v[34:35], v[30:31] op_sel:[0,0] op_sel_hi:[1,0]
    v_pk_fma_f32 v[34:35], v[34:35], v[30:31], v[38:39] op_sel:[1,1,0] op_sel_hi:[0,1,1] neg_lo:[0,1,0]
    v_cvt_pk_f16_f32 v41, v34, -v35
    ds_write_addtid_b32 v41 offset:11696
    v_pk_mul_f32 v[38:39], v[36:37], v[28:29] op_sel:[0,0] op_sel_hi:[1,0]
    v_pk_fma_f32 v[36:37], v[36:37], v[28:29], v[38:39] op_sel:[1,1,0] op_sel_hi:[0,1,1] neg_lo:[0,1,0]
    v_cvt_pk_f16_f32 v40, v36, -v37
    ds_write_addtid_b32 v40 offset:11968
    v_pk_mul_f32 v[38:39], v[36:37], v[32:33] op_sel:[0,0] op_sel_hi:[1,0]
    v_pk_fma_f32 v[34:35], v[36:37], v[32:33], v[38:39] op_sel:[1,1,0] op_sel_hi:[0,1,1] neg_lo:[0,1,0]
    v_cvt_pk_f16_f32 v41, v34, -v35
    ds_write_addtid_b32 v41 offset:12240
    v_pk_mul_f32 v[38:39], v[36:37], v[28:29] op_sel:[0,0] op_sel_hi:[1,0]
    v_pk_fma_f32 v[36:37], v[36:37], v[28:29], v[38:39] op_sel:[1,1,0] op_sel_hi:[0,1,1] neg_lo:[0,1,0]
    v_cvt_pk_f16_f32 v40, v36, -v37
    ds_write_addtid_b32 v40 offset:12512
    v_pk_mul_f32 v[38:39], v[36:37], v[32:33] op_sel:[0,0] op_sel_hi:[1,0]
    v_pk_fma_f32 v[34:35], v[36:37], v[32:33], v[38:39] op_sel:[1,1,0] op_sel_hi:[0,1,1] neg_lo:[0,1,0]
    v_cvt_pk_f16_f32 v41, v34, -v35
    ds_write_addtid_b32 v41 offset:12784
    v_pk_mul_f32 v[38:39], v[36:37], v[28:29] op_sel:[0,0] op_sel_hi:[1,0]
    v_pk_fma_f32 v[36:37], v[36:37], v[28:29], v[38:39] op_sel:[1,1,0] op_sel_hi:[0,1,1] neg_lo:[0,1,0]
    v_cvt_pk_f16_f32 v40, v36, -v37
    ds_write_addtid_b32 v40 offset:13056
    global_load_dword v104, v2, s[4:5]
    v_pk_mul_f32 v[38:39], v[36:37], v[28:29] op_sel:[0,0] op_sel_hi:[1,0]
    v_pk_fma_f32 v[36:37], v[36:37], v[28:29], v[38:39] op_sel:[1,1,0] op_sel_hi:[0,1,1] neg_lo:[0,1,0]
    v_cvt_pk_f16_f32 v41, v36, -v37
    ds_write_addtid_b32 v41 offset:13328
    v_pk_mul_f32 v[38:39], v[36:37], v[28:29] op_sel:[0,0] op_sel_hi:[1,0]
    v_pk_fma_f32 v[36:37], v[36:37], v[28:29], v[38:39] op_sel:[1,1,0] op_sel_hi:[0,1,1] neg_lo:[0,1,0]
    v_cvt_pk_f16_f32 v40, v36, -v37
    ds_write_addtid_b32 v40 offset:13600
    v_pk_mul_f32 v[38:39], v[36:37], v[28:29] op_sel:[0,0] op_sel_hi:[1,0]
    v_pk_fma_f32 v[36:37], v[36:37], v[28:29], v[38:39] op_sel:[1,1,0] op_sel_hi:[0,1,1] neg_lo:[0,1,0]
    v_cvt_pk_f16_f32 v41, v36, -v37
    ds_write_addtid_b32 v41 offset:13872
    v_pk_mul_f32 v[38:39], v[36:37], v[28:29] op_sel:[0,0] op_sel_hi:[1,0]
    v_pk_fma_f32 v[36:37], v[36:37], v[28:29], v[38:39] op_sel:[1,1,0] op_sel_hi:[0,1,1] neg_lo:[0,1,0]
    v_cvt_pk_f16_f32 v40, v36, -v37
    ds_write_addtid_b32 v40 offset:14144
    s_branch L_egen_done
L_c_noln:
    v_and_b32 v10, 255, v0
    v_lshlrev_b32 v10, 1, v10
    s_lshl_b32 s33, s32, 1
    s_add_u32 s33, s33, s37
    s_lshl_b32 s33, s33, 9
    s_add_u32 s12, s12, s33
    s_addc_u32 s13, s13, 0
    s_add_u32 s14, s14, s33
    s_addc_u32 s15, s15, 0
    s_add_u32 s16, s16, s33
    s_addc_u32 s17, s17, 0
    s_add_u32 s18, s18, s33
    s_addc_u32 s19, s19, 0
    v_mov_b32 v124, 0
    v_mov_b32 v125, 0
    v_mov_b32 v126, 0
    v_mov_b32 v127, 0
    global_load_short_d16_hi v124, v10, s[12:13]
    global_load_short_d16_hi v125, v10, s[14:15]
    global_load_short_d16_hi v126, v10, s[16:17]
    global_load_short_d16_hi v127, v10, s[18:19]
    v_lshlrev_b32 v10, 3, v1
    global_load_dwordx2 v[56:57], v10, s[16:17]
    global_load_dwordx2 v[58:59], v10, s[18:19]
    s_lshl_b32 s33, s32, 2
    s_add_u32 s20, s20, s33
    s_addc_u32 s21, s21, 0
    s_add_u32 s22, s22, s33
    s_addc_u32 s23, s23, 0
    s_load_dword s44, s[20:21], 0
    s_load_dword s45, s[22:23], 0
    s_getpc_b64 s[40:41]
    s_add_u32 s40, s40, T1_table@rel32@lo+4
    s_addc_u32 s41, s41, T1_table@rel32@hi+12
    v_mul_u32_u24 v10, 48, v0
    global_load_dwordx4 v[112:115], v10, s[40:41] offset:0
    global_load_dwordx4 v[116:119], v10, s[40:41] offset:16
    global_load_dwordx4 v[120:123], v10, s[40:41] offset:32
    v_mov_b32 v111, v0
    v_mul_u32_u24 v2, 896, v111
    s_lshl_b32 s33, s32, 2
    v_add_u32 v2, s33, v2
    s_add_u32 s60, s4, 458752
    s_addc_u32 s61, s5, 0
    s_add_u32 s62, s10, 458752
    s_addc_u32 s63, s11, 0
    s_add_u32 s42, s4, 917504
    s_addc_u32 s43, s5, 0
    s_add_u32 s98, s10, 917504
    s_addc_u32 s99, s11, 0
    s_add_u32 s96, s4, 1376256
    s_addc_u32 s97, s5, 0
    s_add_u32 s100, s10, 1376256
    s_addc_u32 s101, s11, 0
    v_mov_b32 v10, 0
    v_mov_b32 v11, 0
    v_mov_b32 v12, 0
    v_mov_b32 v13, 0
    v_bfe_u32 v14, v0, 5, 1
    v_mul_u32_u24 v14, 4608, v14
    v_and_b32 v15, 31, v0
    v_lshl_add_u32 v14, v15, 4, v14
    v_add_u32 v14, 118464, v14
    ds_write_b128 v14, v[10:13]
    v_and_b32 v14, 1, v0
    v_mul_u32_u24 v14, 1536, v14
    v_add_u32 v14, 116840, v14
    ds_write_b64 v14, v[10:11]
    s_waitcnt lgkmcnt(0)
    s_lshl_b32 s33, s44, 16
    s_and_b32 s34, s44, 0xffff0000
    s_cmp_eq_u32 s37, 0
    s_cselect_b32 s52, s33, s34
    v_mov_b32 v22, 0x3fb8aa3b
    v_mov_b32 v23, 0x32a57060
    v_mul_f32 v80, s52, v22
    v_fma_f32 v82, s52, v22, -v80
    v_exp_f32 v80, v80
    v_fma_f32 v82, s52, v23, v82
    v_mul_f32 v82, 0x3f317218, v82
    v_fma_f32 v80, v80, v82, v80
    v_cvt_pk_bf16_f32 v84, v80, v80
    v_lshlrev_b32 v18, 16, v84
    v_mul_f32 v19, 0xbfb8aa3b, v18
    v_mul_f32 v20, 0x3e22f983, v18
    v_add_f32 v21, v18, v18
    s_mul_i32 s48, s30, 14416
    v_and_b32 v80, 31, v1
    v_lshrrev_b32 v81, 5, v1
    v_mul_u32_u24 v96, 272, v80
    v_lshl_add_u32 v96, v81, 4, v96
    v_add_u32 v96, s48, v96
    v_min_u32 v82, 20, v80
    v_mul_u32_u24 v97, 272, v82
    v_lshl_add_u32 v97, v81, 4, v97
    v_add_u32 v97, s48, v97
    v_add_u32 v97, 8704, v97
    v_mul_u32_u24 v98, 144, v80
    v_lshl_add_u32 v98, v81, 4, v98
    v_add_u32 v98, s48, v98
    s_waitcnt lgkmcnt(0)
    s_add_u32 s31, s31, 0x9e3779b9
    s_waitcnt vmcnt(3)
    v_mul_f32 v124, v22, v124
    v_lshlrev_b32 v85, 16, v56
    v_and_b32 v86, 0xffff0000, v56
    v_add_f32 v81, |v85|, |v86|
    v_exp_f32 v124, v124
    v_lshlrev_b32 v85, 16, v57
    v_and_b32 v86, 0xffff0000, v57
    v_add_f32 v81, |v85|, v81
    v_add_f32 v81, |v86|, v81
    v_lshlrev_b32 v85, 16, v58
    v_and_b32 v86, 0xffff0000, v58
    v_add_f32 v81, |v85|, v81
    v_add_f32 v81, |v86|, v81
    v_lshlrev_b32 v85, 16, v59
    v_and_b32 v86, 0xffff0000, v59
    v_add_f32 v81, |v85|, v81
    v_add_f32 v81, |v86|, v81
    v_cvt_pk_bf16_f32 v84, v124, v124
    s_nop 0
    v_add_f32_dpp v81, v81, v81 row_shr:1 row_mask:0xf bank_mask:0xf bound_ctrl:0
    s_nop 1
    v_add_f32_dpp v81, v81, v81 row_shr:2 row_mask:0xf bank_mask:0xf bound_ctrl:0
    s_nop 1
    v_add_f32_dpp v81, v81, v81 row_shr:4 row_mask:0xf bank_mask:0xf bound_ctrl:0
    s_nop 1
    v_add_f32_dpp v81, v81, v81 row_shr:8 row_mask:0xf bank_mask:0xf bound_ctrl:0
    s_nop 1
    v_add_f32_dpp v81, v81, v81 row_bcast:15 row_mask:0xa bank_mask:0xf
    s_nop 1
    v_add_f32_dpp v81, v81, v81 row_bcast:31 row_mask:0xc bank_mask:0xf
    v_lshlrev_b32 v124, 16, v84
    v_readlane_b32 s54, v81, 63
    s_nop 1
    v_mul_f32 v91, s54, v21
    v_frexp_exp_i32_f32 v80, v91
    v_sub_u32 v82, 14, v80
    v_subrev_u32 v80, 14, v80
    v_ldexp_f32 v48, v21, v82
    v_ldexp_f32 v92, 1.0, v80
    s_lshl_b32 s33, s37, 2
    s_add_u32 s33, s33, 118400
    v_mov_b32 v85, s33
    s_mov_b64 exec, 1
    ds_write_b32 v85, v92
    s_mov_b64 exec, -1
    v_mul_f32 v42, v124, v19
    v_mul_f32 v43, v125, v20
    v_exp_f32 v44, v42
    v_fract_f32 v45, v43
    v_cos_f32 v46, v45
    v_sin_f32 v47, v45
    s_nop 0
    v_pk_mul_f32 v[24:25], v[46:47], v[44:45] op_sel:[0,0] op_sel_hi:[1,0]
    v_mul_f32 v44, 0x41000000, v42
    v_mul_f32 v45, 0x41000000, v43
    v_exp_f32 v44, v44
    v_fract_f32 v45, v45
    v_cos_f32 v46, v45
    v_sin_f32 v47, v45
    s_nop 0
    v_pk_mul_f32 v[26:27], v[46:47], v[44:45] op_sel:[0,0] op_sel_hi:[1,0]
    v_mul_f32 v44, 0x43800000, v42
    v_mul_f32 v45, 0x43800000, v43
    v_exp_f32 v44, v44
    v_fract_f32 v45, v45
    v_cos_f32 v46, v45
    v_sin_f32 v47, v45
    s_nop 0
    v_pk_mul_f32 v[28:29], v[46:47], v[44:45] op_sel:[0,0] op_sel_hi:[1,0]
    v_pk_mul_f32 v[36:37], v[126:127], v[48:49] op_sel:[0,0] op_sel_hi:[1,0]
    s_sub_u32 s34, s48, 49472
    s_mov_b32 m0, s34
    s_cmp_eq_u32 s30, 7
    s_cbranch_scc1 L_nopf
    s_mul_i32 s33, s51, 3
    s_add_u32 s33, s33, s30
    s_sub_u32 s33, s33, 4
    s_mul_i32 s34, s33, 3121
    s_lshr_b32 s34, s34, 16
    s_mul_i32 s35, s34, 21
    s_sub_u32 s33, s33, s35
    s_lshl_b32 s34, s34, 3
    s_and_b32 s35, s2, 7
    s_add_u32 s34, s34, s35
    s_cmp_ge_u32 s34, 28
    s_cbranch_scc1 L_nopf
    s_mul_i32 s35, s33, 9363
    s_lshr_b32 s35, s35, 16
    s_mul_i32 s36, s35, 7
    s_sub_u32 s33, s33, s36
    s_lshl_b32 s33, s33, 6
    v_add_u32 v60, s33, v1
    s_cmp_eq_u32 s35, 2
    s_cbranch_scc1 L_pf_down
    s_lshl_b32 s34, s34, 7
    v_mul_u32_u24 v60, 3584, v60
    v_add_u32 v60, s34, v60
    s_cmp_eq_u32 s35, 0
    s_cbranch_scc1 L_pf_gate
    global_load_dword v61, v60, s[26:27]
    s_branch L_nopf
L_pf_gate:
    global_load_dword v61, v60, s[24:25]
    s_branch L_nopf
L_pf_down:
    s_mul_i32 s34, s34, 57344
    v_lshlrev_b32 v60, 7, v60
    v_add_u32 v60, s34, v60
    global_load_dword v61, v60, s[28:29]
    s_nop 0
L_nopf:
    v_mov_b32 v40, 0x00003c00
    ds_write_addtid_b32 v40 offset:49472
    v_cvt_pk_f16_f32 v50, v26, v27
    ds_write_addtid_b32 v50 offset:49744
    v_pk_mul_f32 v[38:39], v[26:27], v[26:27] op_sel:[0,0] op_sel_hi:[1,0]
    v_pk_fma_f32 v[34:35], v[26:27], v[26:27], v[38:39] op_sel:[1,1,0] op_sel_hi:[0,1,1] neg_lo:[0,1,0]
    v_cvt_pk_f16_f32 v51, v34, v35
    ds_write_addtid_b32 v51 offset:50016
    v_pk_mul_f32 v[38:39], v[34:35], v[26:27] op_sel:[0,0] op_sel_hi:[1,0]
    v_pk_fma_f32 v[30:31], v[34:35], v[26:27], v[38:39] op_sel:[1,1,0] op_sel_hi:[0,1,1] neg_lo:[0,1,0]
    v_cvt_pk_f16_f32 v52, v30, v31
    ds_write_addtid_b32 v52 offset:50288
    v_pk_mul_f32 v[38:39], v[34:35], v[34:35] op_sel:[0,0] op_sel_hi:[1,0]
    v_pk_fma_f32 v[32:33], v[34:35], v[34:35], v[38:39] op_sel:[1,1,0] op_sel_hi:[0,1,1] neg_lo:[0,1,0]
    v_cvt_pk_f16_f32 v53, v32, v33
    ds_write_addtid_b32 v53 offset:50560
    v_pk_mul_f16 v54, v53, v50 op_sel:[0,0] op_sel_hi:[1,0]
    v_pk_fma_f16 v41, v53, v50, v54 op_sel:[1,1,0] op_sel_hi:[0,1,1] neg_lo:[0,1,0]
    ds_write_addtid_b32 v41 offset:50832
    v_pk_mul_f16 v54, v53, v51 op_sel:[0,0] op_sel_hi:[1,0]
    v_pk_fma_f16 v40, v53, v51, v54 op_sel:[1,1,0] op_sel_hi:[0,1,1] neg_lo:[0,1,0]
    ds_write_addtid_b32 v40 offset:51104
    v_pk_mul_f16 v54, v53, v52 op_sel:[0,0] op_sel_hi:[1,0]
    v_pk_fma_f16 v41, v53, v52, v54 op_sel:[1,1,0] op_sel_hi:[0,1,1] neg_lo:[0,1,0]
    ds_write_addtid_b32 v41 offset:51376
    v_pk_mul_f32 v[38:39], v[32:33], v[32:33] op_sel:[0,0] op_sel_hi:[1,0]
    v_pk_fma_f32 v[34:35], v[32:33], v[32:33], v[38:39] op_sel:[1,1,0] op_sel_hi:[0,1,1] neg_lo:[0,1,0]
    v_cvt_pk_f16_f32 v53, v34, v35
    ds_write_addtid_b32 v53 offset:51648
    v_pk_mul_f16 v54, v53, v50 op_sel:[0,0] op_sel_hi:[1,0]
    v_pk_fma_f16 v40, v53, v50, v54 op_sel:[1,1,0] op_sel_hi:[0,1,1] neg_lo:[0,1,0]
    ds_write_addtid_b32 v40 offset:51920
    v_pk_mul_f16 v54, v53, v51 op_sel:[0,0] op_sel_hi:[1,0]
    v_pk_fma_f16 v41, v53, v51, v54 op_sel:[1,1,0] op_sel_hi:[0,1,1] neg_lo:[0,1,0]
    ds_write_addtid_b32 v41 offset:52192
    v_pk_mul_f16 v54, v53, v52 op_sel:[0,0] op_sel_hi:[1,0]
    v_pk_fma_f16 v40, v53, v52, v54 op_sel:[1,1,0] op_sel_hi:[0,1,1] neg_lo:[0,1,0]
    ds_write_addtid_b32 v40 offset:52464
    v_pk_mul_f32 v[38:39], v[34:35], v[32:33] op_sel:[0,0] op_sel_hi:[1,0]
    v_pk_fma_f32 v[34:35], v[34:35], v[32:33], v[38:39] op_sel:[1,1,0] op_sel_hi:[0,1,1] neg_lo:[0,1,0]
    v_cvt_pk_f16_f32 v53, v34, v35
    ds_write_addtid_b32 v53 offset:52736
    v_pk_mul_f16 v54, v53, v50 op_sel:[0,0] op_sel_hi:[1,0]
    v_pk_fma_f16 v41, v53, v50, v54 op_sel:[1,1,0] op_sel_hi:[0,1,1] neg_lo:[0,1,0]
    ds_write_addtid_b32 v41 offset:53008
    v_pk_mul_f16 v54, v53, v51 op_sel:[0,0] op_sel_hi:[1,0]
    v_pk_fma_f16 v40, v53, v51, v54 op_sel:[1,1,0] op_sel_hi:[0,1,1] neg_lo:[0,1,0]
    ds_write_addtid_b32 v40 offset:53280
    v_pk_mul_f16 v54, v53, v52 op_sel:[0,0] op_sel_hi:[1,0]
    v_pk_fma_f16 v41, v53, v52, v54 op_sel:[1,1,0] op_sel_hi:[0,1,1] neg_lo:[0,1,0]
    ds_write_addtid_b32 v41 offset:53552
    v_pk_mul_f32 v[38:39], v[34:35], v[32:33] op_sel:[0,0] op_sel_hi:[1,0]
    v_pk_fma_f32 v[34:35], v[34:35], v[32:33], v[38:39] op_sel:[1,1,0] op_sel_hi:[0,1,1] neg_lo:[0,1,0]
    v_cvt_pk_f16_f32 v53, v34, v35
    ds_write_addtid_b32 v53 offset:53824
    v_pk_mul_f16 v54, v53, v50 op_sel:[0,0] op_sel_hi:[1,0]
    v_pk_fma_f16 v40, v53, v50, v54 op_sel:[1,1,0] op_sel_hi:[0,1,1] neg_lo:[0,1,0]
    ds_write_addtid_b32 v40 offset:54096
    v_pk_mul_f16 v54, v53, v51 op_sel:[0,0] op_sel_hi:[1,0]
    v_pk_fma_f16 v41, v53, v51, v54 op_sel:[1,1,0] op_sel_hi:[0,1,1] neg_lo:[0,1,0]
    ds_write_addtid_b32 v41 offset:54368
    v_pk_mul_f16 v54, v53, v52 op_sel:[0,0] op_sel_hi:[1,0]
    v_pk_fma_f16 v40, v53, v52, v54 op_sel:[1,1,0] op_sel_hi:[0,1,1] neg_lo:[0,1,0]
    ds_write_addtid_b32 v40 offset:54640
    v_pk_mul_f32 v[38:39], v[34:35], v[32:33] op_sel:[0,0] op_sel_hi:[1,0]
    v_pk_fma_f32 v[34:35], v[34:35], v[32:33], v[38:39] op_sel:[1,1,0] op_sel_hi:[0,1,1] neg_lo:[0,1,0]
    v_cvt_pk_f16_f32 v53, v34, v35
    ds_write_addtid_b32 v53 offset:54912
    v_pk_mul_f16 v54, v53, v50 op_sel:[0,0] op_sel_hi:[1,0]
    v_pk_fma_f16 v41, v53, v50, v54 op_sel:[1,1,0] op_sel_hi:[0,1,1] neg_lo:[0,1,0]
    ds_write_addtid_b32 v41 offset:55184
    v_pk_mul_f16 v54, v53, v51 op_sel:[0,0] op_sel_hi:[1,0]
    v_pk_fma_f16 v40, v53, v51, v54 op_sel:[1,1,0] op_sel_hi:[0,1,1] neg_lo:[0,1,0]
    ds_write_addtid_b32 v40 offset:55456
    v_pk_mul_f16 v54, v53, v52 op_sel:[0,0] op_sel_hi:[1,0]
    v_pk_fma_f16 v41, v53, v52, v54 op_sel:[1,1,0] op_sel_hi:[0,1,1] neg_lo:[0,1,0]
    ds_write_addtid_b32 v41 offset:55728
    v_pk_mul_f32 v[38:39], v[34:35], v[32:33] op_sel:[0,0] op_sel_hi:[1,0]
    v_pk_fma_f32 v[34:35], v[34:35], v[32:33], v[38:39] op_sel:[1,1,0] op_sel_hi:[0,1,1] neg_lo:[0,1,0]
    v_cvt_pk_f16_f32 v53, v34, v35
    ds_write_addtid_b32 v53 offset:56000
    v_pk_mul_f16 v54, v53, v50 op_sel:[0,0] op_sel_hi:[1,0]
    v_pk_fma_f16 v40, v53, v50, v54 op_sel:[1,1,0] op_sel_hi:[0,1,1] neg_lo:[0,1,0]
    ds_write_addtid_b32 v40 offset:56272
    v_pk_mul_f16 v54, v53, v51 op_sel:[0,0] op_sel_hi:[1,0]
    v_pk_fma_f16 v41, v53, v51, v54 op_sel:[1,1,0] op_sel_hi:[0,1,1] neg_lo:[0,1,0]
    ds_write_addtid_b32 v41 offset:56544
    v_pk_mul_f16 v54, v53, v52 op_sel:[0,0] op_sel_hi:[1,0]
    v_pk_fma_f16 v40, v53, v52, v54 op_sel:[1,1,0] op_sel_hi:[0,1,1] neg_lo:[0,1,0]
    ds_write_addtid_b32 v40 offset:56816
    v_pk_mul_f32 v[38:39], v[34:35], v[32:33] op_sel:[0,0] op_sel_hi:[1,0]
    v_pk_fma_f32 v[34:35], v[34:35], v[32:33], v[38:39] op_sel:[1,1,0] op_sel_hi:[0,1,1] neg_lo:[0,1,0]
    v_cvt_pk_f16_f32 v53, v34, v35
    ds_write_addtid_b32 v53 offset:57088
    v_pk_mul_f16 v54, v53, v50 op_sel:[0,0] op_sel_hi:[1,0]
    v_pk_fma_f16 v41, v53, v50, v54 op_sel:[1,1,0] op_sel_hi:[0,1,1] neg_lo:[0,1,0]
    ds_write_addtid_b32 v41 offset:57360
    v_pk_mul_f16 v54, v53, v51 op_sel:[0,0] op_sel_hi:[1,0]
    v_pk_fma_f16 v40, v53, v51, v54 op_sel:[1,1,0] op_sel_hi:[0,1,1] neg_lo:[0,1,0]
    ds_write_addtid_b32 v40 offset:57632
    v_pk_mul_f16 v54, v53, v52 op_sel:[0,0] op_sel_hi:[1,0]
    v_pk_fma_f16 v41, v53, v52, v54 op_sel:[1,1,0] op_sel_hi:[0,1,1] neg_lo:[0,1,0]
    ds_write_addtid_b32 v41 offset:57904
    v_cvt_pk_f16_f32 v40, v36, -v37
    ds_write_addtid_b32 v40 offset:58176
    v_pk_mul_f32 v[38:39], v[36:37], v[24:25] op_sel:[0,0] op_sel_hi:[1,0]
    v_pk_fma_f32 v[34:35], v[36:37], v[24:25], v[38:39] op_sel:[1,1,0] op_sel_hi:[0,1,1] neg_lo:[0,1,0]
    v_cvt_pk_f16_f32 v41, v34, -v35
    ds_write_addtid_b32 v41 offset:58448
    v_pk_mul_f32 v[38:39], v[34:35], v[24:25] op_sel:[0,0] op_sel_hi:[1,0]
    v_pk_fma_f32 v[34:35], v[34:35], v[24:25], v[38:39] op_sel:[1,1,0] op_sel_hi:[0,1,1] neg_lo:[0,1,0]
    v_cvt_pk_f16_f32 v40, v34, -v35
    ds_write_addtid_b32 v40 offset:58720
    v_pk_mul_f32 v[38:39], v[34:35], v[24:25] op_sel:[0,0] op_sel_hi:[1,0]
    v_pk_fma_f32 v[34:35], v[34:35], v[24:25], v[38:39] op_sel:[1,1,0] op_sel_hi:[0,1,1] neg_lo:[0,1,0]
    v_cvt_pk_f16_f32 v41, v34, -v35
    ds_write_addtid_b32 v41 offset:58992
    v_pk_mul_f32 v[38:39], v[34:35], v[24:25] op_sel:[0,0] op_sel_hi:[1,0]
    v_pk_fma_f32 v[34:35], v[34:35], v[24:25], v[38:39] op_sel:[1,1,0] op_sel_hi:[0,1,1] neg_lo:[0,1,0]
    v_cvt_pk_f16_f32 v40, v34, -v35
    ds_write_addtid_b32 v40 offset:59264
    v_pk_mul_f32 v[38:39], v[34:35], v[24:25] op_sel:[0,0] op_sel_hi:[1,0]
    v_pk_fma_f32 v[34:35], v[34:35], v[24:25], v[38:39] op_sel:[1,1,0] op_sel_hi:[0,1,1] neg_lo:[0,1,0]
    v_cvt_pk_f16_f32 v41, v34, -v35
    ds_write_addtid_b32 v41 offset:59536
    v_pk_mul_f32 v[38:39], v[34:35], v[24:25] op_sel:[0,0] op_sel_hi:[1,0]
    v_pk_fma_f32 v[34:35], v[34:35], v[24:25], v[38:39] op_sel:[1,1,0] op_sel_hi:[0,1,1] neg_lo:[0,1,0]
    v_cvt_pk_f16_f32 v40, v34, -v35
    ds_write_addtid_b32 v40 offset:59808
    v_pk_mul_f32 v[38:39], v[34:35], v[24:25] op_sel:[0,0] op_sel_hi:[1,0]
    v_pk_fma_f32 v[34:35], v[34:35], v[24:25], v[38:39] op_sel:[1,1,0] op_sel_hi:[0,1,1] neg_lo:[0,1,0]
    v_cvt_pk_f16_f32 v41, v34, -v35
    ds_write_addtid_b32 v41 offset:60080
    v_pk_mul_f32 v[38:39], v[24:25], v[24:25] op_sel:[0,0] op_sel_hi:[1,0]
    v_pk_fma_f32 v[30:31], v[24:25], v[24:25], v[38:39] op_sel:[1,1,0] op_sel_hi:[0,1,1] neg_lo:[0,1,0]
    v_pk_mul_f32 v[38:39], v[30:31], v[30:31] op_sel:[0,0] op_sel_hi:[1,0]
    v_pk_fma_f32 v[32:33], v[30:31], v[30:31], v[38:39] op_sel:[1,1,0] op_sel_hi:[0,1,1] neg_lo:[0,1,0]
    v_pk_mul_f32 v[38:39], v[36:37], v[28:29] op_sel:[0,0] op_sel_hi:[1,0]
    v_pk_fma_f32 v[36:37], v[36:37], v[28:29], v[38:39] op_sel:[1,1,0] op_sel_hi:[0,1,1] neg_lo:[0,1,0]
    v_cvt_pk_f16_f32 v40, v36, -v37
    ds_write_addtid_b32 v40 offset:60352
    v_pk_mul_f32 v[38:39], v[36:37], v[30:31] op_sel:[0,0] op_sel_hi:[1,0]
    v_pk_fma_f32 v[34:35], v[36:37], v[30:31], v[38:39] op_sel:[1,1,0] op_sel_hi:[0,1,1] neg_lo:[0,1,0]
    v_cvt_pk_f16_f32 v41, v34, -v35
    ds_write_addtid_b32 v41 offset:60624
    v_pk_mul_f32 v[38:39], v[34:35], v[30:31] op_sel:[0,0] op_sel_hi:[1,0]
    v_pk_fma_f32 v[34:35], v[34:35], v[30:31], v[38:39] op_sel:[1,1,0] op_sel_hi:[0,1,1] neg_lo:[0,1,0]
    v_cvt_pk_f16_f32 v40, v34, -v35
    ds_write_addtid_b32 v40 offset:60896
    v_pk_mul_f32 v[38:39], v[34:35], v[30:31] op_sel:[0,0] op_sel_hi:[1,0]
    v_pk_fma_f32 v[34:35], v[34:35], v[30:31], v[38:39] op_sel:[1,1,0] op_sel_hi:[0,1,1] neg_lo:[0,1,0]
    v_cvt_pk_f16_f32 v41, v34, -v35
    ds_write_addtid_b32 v41 offset:61168
    v_pk_mul_f32 v[38:39], v[36:37], v[28:29] op_sel:[0,0] op_sel_hi:[1,0]
    v_pk_fma_f32 v[36:37], v[36:37], v[28:29], v[38:39] op_sel:[1,1,0] op_sel_hi:[0,1,1] neg_lo:[0,1,0]
    v_cvt_pk_f16_f32 v40, v36, -v37
    ds_write_addtid_b32 v40 offset:61440
    v_pk_mul_f32 v[38:39], v[36:37], v[32:33] op_sel:[0,0] op_sel_hi:[1,0]
    v_pk_fma_f32 v[34:35], v[36:37], v[32:33], v[38:39] op_sel:[1,1,0] op_sel_hi:[0,1,1] neg_lo:[0,1,0]
    v_cvt_pk_f16_f32 v41, v34, -v35
    ds_write_addtid_b32 v41 offset:61712
    v_pk_mul_f32 v[38:39], v[36:37], v[28:29] op_sel:[0,0] op_sel_hi:[1,0]
    v_pk_fma_f32 v[36:37], v[36:37], v[28:29], v[38:39] op_sel:[1,1,0] op_sel_hi:[0,1,1] neg_lo:[0,1,0]
    v_cvt_pk_f16_f32 v40, v36, -v37
    ds_write_addtid_b32 v40 offset:61984
    v_pk_mul_f32 v[38:39], v[36:37], v[32:33] op_sel:[0,0] op_sel_hi:[1,0]
    v_pk_fma_f32 v[34:35], v[36:37], v[32:33], v[38:39] op_sel:[1,1,0] op_sel_hi:[0,1,1] neg_lo:[0,1,0]
    v_cvt_pk_f16_f32 v41, v34, -v35
    ds_write_addtid_b32 v41 offset:62256
    v_pk_mul_f32 v[38:39], v[36:37], v[28:29] op_sel:[0,0] op_sel_hi:[1,0]
    v_pk_fma_f32 v[36:37], v[36:37], v[28:29], v[38:39] op_sel:[1,1,0] op_sel_hi:[0,1,1] neg_lo:[0,1,0]
    v_cvt_pk_f16_f32 v40, v36, -v37
    ds_write_addtid_b32 v40 offset:62528
    v_pk_mul_f32 v[38:39], v[36:37], v[28:29] op_sel:[0,0] op_sel_hi:[1,0]
    v_pk_fma_f32 v[36:37], v[36:37], v[28:29], v[38:39] op_sel:[1,1,0] op_sel_hi:[0,1,1] neg_lo:[0,1,0]
    v_cvt_pk_f16_f32 v41, v36, -v37
    ds_write_addtid_b32 v41 offset:62800
    v_pk_mul_f32 v[38:39], v[36:37], v[28:29] op_sel:[0,0] op_sel_hi:[1,0]
    v_pk_fma_f32 v[36:37], v[36:37], v[28:29], v[38:39] op_sel:[1,1,0] op_sel_hi:[0,1,1] neg_lo:[0,1,0]
    v_cvt_pk_f16_f32 v40, v36, -v37
    ds_write_addtid_b32 v40 offset:63072
    global_load_dword v104, v2, s[4:5]
    v_pk_mul_f32 v[38:39], v[36:37], v[28:29] op_sel:[0,0] op_sel_hi:[1,0]
    v_pk_fma_f32 v[36:37], v[36:37], v[28:29], v[38:39] op_sel:[1,1,0] op_sel_hi:[0,1,1] neg_lo:[0,1,0]
    v_cvt_pk_f16_f32 v41, v36, -v37
    ds_write_addtid_b32 v41 offset:63344
    v_pk_mul_f32 v[38:39], v[36:37], v[28:29] op_sel:[0,0] op_sel_hi:[1,0]
    v_pk_fma_f32 v[36:37], v[36:37], v[28:29], v[38:39] op_sel:[1,1,0] op_sel_hi:[0,1,1] neg_lo:[0,1,0]
    v_cvt_pk_f16_f32 v40, v36, -v37
    ds_write_addtid_b32 v40 offset:63616
    s_nop 0
L_egen_done:
    ds_read_b128 a[0:3], v96 offset:0
    ds_read_b128 a[4:7], v97 offset:0
    ds_read_b128 a[8:11], v96 offset:32
    ds_read_b128 a[12:15], v97 offset:32
    ds_read_b128 a[16:19], v96 offset:64
    ds_read_b128 a[20:23], v97 offset:64
    ds_read_b128 a[24:27], v96 offset:96
    ds_read_b128 a[28:31], v97 offset:96
    ds_read_b128 a[32:35], v96 offset:128
    ds_read_b128 a[36:39], v97 offset:128
    ds_read_b128 a[40:43], v96 offset:160
    ds_read_b128 a[44:47], v97 offset:160
    ds_read_b128 a[48:51], v96 offset:192
    ds_read_b128 a[52:55], v97 offset:192
    ds_read_b128 a[56:59], v96 offset:224
    ds_read_b128 a[60:63], v97 offset:224
    v_lshlrev_b32 v108, 4, v111
    v_add_u32 v108, 4096, v108
    v_add_u32 v109, 8192, v108
    global_load_dwordx4 v[10:13], v108, s[8:9] offset:0 sc1
    global_load_dwordx4 v[14:17], v109, s[8:9] offset:0 sc1
    global_load_dword v105, v2, s[60:61]
    s_waitcnt lgkmcnt(14)
    v_mfma_f32_32x32x16_f16 v[64:79], a[0:3], a[4:7], 0
    v_and_b32 v99, 255, v0
    v_min_u32 v99, 188, v99
    s_mul_i32 s33, s37, 1536
    s_add_u32 s33, s33, 115328
    v_lshlrev_b32 v100, 3, v99
    v_add_u32 v100, s33, v100
    s_mul_i32 s33, s37, 57664
    v_lshlrev_b32 v99, 4, v99
    v_add_u32 v99, s33, v99
    v_bfe_u32 v102, v0, 3, 1
    s_waitcnt lgkmcnt(12)
    v_mfma_f32_32x32x16_f16 v[64:79], a[8:11], a[12:15], v[64:79]
    v_mul_u32_u24 v102, 16640, v102
    v_bfe_u32 v80, v0, 1, 2
    v_mul_u32_u24 v80, 4160, v80
    v_add_u32 v102, v102, v80
    v_and_b32 v80, 1, v0
    v_lshl_add_u32 v102, v80, 4, v102
    v_and_b32 v101, 255, v0
    v_lshlrev_b32 v101, 4, v101
    s_mul_i32 s33, s37, 16640
    v_add_u32 v101, s33, v101
    s_waitcnt lgkmcnt(10)
    v_mfma_f32_32x32x16_f16 v[64:79], a[16:19], a[20:23], v[64:79]
    v_lshlrev_b32 v110, 1, v111
    v_add_u32 v110, 118976, v110
    v_lshrrev_b32 v80, 4, v111
    v_bfe_u32 v81, v111, 5, 2
    v_bfe_u32 v82, v111, 2, 2
    v_xor_b32 v81, v81, v82
    v_lshlrev_b32 v3, 6, v80
    v_lshl_add_u32 v3, v81, 4, v3
    v_and_b32 v80, 3, v111
    v_lshl_add_u32 v3, v80, 2, v3
    s_waitcnt lgkmcnt(8)
    v_mfma_f32_32x32x16_f16 v[64:79], a[24:27], a[28:31], v[64:79]
    v_add_u32 v3, 33792, v3
    v_and_b32 v80, 15, v1
    v_lshrrev_b32 v81, 4, v1
    v_sub_u32 v82, 3, v80
    v_and_b32 v82, 3, v82
    v_mul_u32_u24 v62, 4160, v82
    v_lshl_add_u32 v62, v81, 4, v62
    v_lshrrev_b32 v83, 2, v80
    v_lshlrev_b32 v83, 3, v83
    v_sub_u32 v62, v62, v83
    s_waitcnt lgkmcnt(6)
    v_mfma_f32_32x32x16_f16 v[64:79], a[32:35], a[36:39], v[64:79]
    s_and_b32 s35, s30, 3
    s_mul_i32 s34, s37, 16640
    s_add_u32 s34, s34, 536
    s_lshl_b32 s36, s35, 7
    s_sub_u32 s34, s34, s36
    v_add_u32 v62, s34, v62
    v_lshlrev_b32 v4, 5, v80
    v_lshl_add_u32 v4, v81, 4, v4
    s_mul_i32 s34, s37, 4608
    s_add_u32 s34, s34, 118464
    s_waitcnt lgkmcnt(4)
    v_mfma_f32_32x32x16_f16 v[64:79], a[40:43], a[44:47], v[64:79]
    s_sub_u32 s34, s34, s36
    v_add_u32 v4, s34, v4
    v_bfe_u32 v82, v80, 1, 2
    v_xor_b32 v82, v82, v81
    v_lshlrev_b32 v5, 6, v80
    v_lshl_add_u32 v5, v82, 4, v5
    s_mul_i32 s34, s37, 8192
    s_mul_i32 s36, s35, 16384
    s_add_u32 s34, s34, s36
    s_add_u32 s34, s34, 33792
    s_waitcnt lgkmcnt(2)
    v_mfma_f32_32x32x16_f16 v[64:79], a[48:51], a[52:55], v[64:79]
    v_add_u32 v5, s34, v5
    s_lshl_b32 s52, s45, 16
    s_and_b32 s53, s45, 0xffff0000
    v_mov_b32 v8, s52
    v_mov_b32 v9, s53
    s_waitcnt lgkmcnt(0)
    v_mfma_f32_32x32x16_f16 v[64:79], a[56:59], a[60:63], v[64:79]
    s_mov_b32 exec_lo, 0x001fffff
    s_mov_b32 exec_hi, 0x001fffff
    s_nop 9
    ds_write_b128 v98, v[64:67] offset:0
    ds_write_b128 v98, v[68:71] offset:32
    ds_write_b128 v98, v[72:75] offset:64
    ds_write_b128 v98, v[76:79] offset:96
    s_mov_b64 exec, -1
    s_waitcnt lgkmcnt(0)
    s_barrier
    ds_read_b128 v[64:67], v99 offset:0
    ds_read_b128 v[68:71], v99 offset:14416
    ds_read_b128 v[72:75], v99 offset:28832
    ds_read_b128 v[76:79], v99 offset:43248
    v_mov_b32 v80, 118400
    ds_read_b64 v[6:7], v80
    s_waitcnt lgkmcnt(3)
    v_pk_add_f32 v[64:65], v[64:65], v[68:69]
    s_waitcnt lgkmcnt(1)
    v_pk_add_f32 v[72:73], v[72:73], v[76:77]
    v_pk_add_f32 v[66:67], v[66:67], v[70:71]
    v_pk_add_f32 v[74:75], v[74:75], v[78:79]
    v_pk_add_f32 v[64:65], v[64:65], v[72:73]
    v_pk_add_f32 v[66:67], v[66:67], v[74:75]
    v_cvt_pk_f16_f32 v68, v64, v65
    v_cvt_pk_f16_f32 v69, v66, v67
    ds_write_b64 v100, v[68:69]
    s_waitcnt lgkmcnt(0)
    s_barrier
    s_waitcnt vmcnt(4)
    ds_read_u16 v64, v112
    ds_read_u16 v65, v113
    ds_read_u16 v66, v114
    ds_read_u16 v67, v115
    ds_read_u16 v68, v116
    ds_read_u16 v69, v117
    ds_read_u16 v70, v118
    ds_read_u16 v71, v119
    ds_read_u16 v72, v120
    ds_read_u16 v73, v121
    ds_read_u16 v74, v122
    ds_read_u16 v75, v123
    global_load_dword v106, v2, s[42:43]
    v_mov_b32 v76, 0
    v_mov_b32 v77, 0
    v_mov_b32 v78, 0
    v_mov_b32 v79, 0
    ds_write_b128 v102, v[76:79] offset:4608
    s_waitcnt lgkmcnt(11)
    v_lshl_or_b32 v84, v65, 16, v64
    s_waitcnt lgkmcnt(9)
    v_lshl_or_b32 v85, v67, 16, v66
    s_waitcnt lgkmcnt(7)
    v_lshl_or_b32 v86, v69, 16, v68
    s_waitcnt lgkmcnt(5)
    v_lshl_or_b32 v87, v71, 16, v70
    ds_write_b128 v101, v[84:87] offset:512
    v_lshl_or_b32 v88, v66, 16, v65
    v_lshl_or_b32 v89, v68, 16, v67
    v_lshl_or_b32 v90, v70, 16, v69
    s_waitcnt lgkmcnt(5)
    v_lshl_or_b32 v91, v72, 16, v71
    ds_write_b128 v101, v[88:91] offset:4672
    v_lshl_or_b32 v84, v67, 16, v66
    v_lshl_or_b32 v85, v69, 16, v68
    v_lshl_or_b32 v86, v71, 16, v70
    s_waitcnt lgkmcnt(5)
    v_lshl_or_b32 v87, v73, 16, v72
    ds_write_b128 v101, v[84:87] offset:8832
    v_lshl_or_b32 v88, v68, 16, v67
    v_lshl_or_b32 v89, v70, 16, v69
    v_lshl_or_b32 v90, v72, 16, v71
    s_waitcnt lgkmcnt(5)
    v_lshl_or_b32 v91, v74, 16, v73
    ds_write_b128 v101, v[88:91] offset:12992
    s_mov_b32 s50, 0
    s_waitcnt vmcnt(1)
L_rec_chk:
    v_cmp_ne_u32 vcc, s31, v10
    v_cmp_ne_u32 s[38:39], s31, v14
    s_nop 0
    s_or_b64 vcc, vcc, s[38:39]
    s_cbranch_vccz L_rec_ok
    s_add_u32 s50, s50, 1
    s_cmp_gt_u32 s50, 65536
    s_cbranch_scc1 L_rec_ok
    global_load_dwordx4 v[10:13], v108, s[8:9] offset:0 sc1
    global_load_dwordx4 v[14:17], v109, s[8:9] offset:0 sc1
    s_waitcnt vmcnt(0)
    s_branch L_rec_chk
L_rec_ok:
    v_add_u32 v111, 2048, v62
    v_and_b32 v56, 0xffff0000, v11
    v_lshlrev_b32 v54, 16, v11
    v_rcp_f32 v56, v56
    v_lshlrev_b32 v18, 16, v104
    v_and_b32 v19, 0xffff0000, v104
    v_pk_add_f32 v[58:59], v[18:19], v[54:55] op_sel:[0,0] op_sel_hi:[1,0] neg_lo:[0,1] neg_hi:[0,1]
    v_cvt_pk_bf16_f32 v60, v58, v59
    v_lshlrev_b32 v58, 16, v60
    v_and_b32 v59, 0xffff0000, v60
    v_pk_mul_f32 v[58:59], v[58:59], v[56:57] op_sel:[0,0] op_sel_hi:[1,0]
    v_cvt_pk_bf16_f32 v60, v58, v59
    v_lshlrev_b32 v96, 16, v60
    v_and_b32 v97, 0xffff0000, v60
    v_cvt_pk_f16_f32 v61, v96, v97
    ds_write_b16 v110, v61 offset:0
    ds_write_b16_d16_hi v110, v61 offset:4608
    v_and_b32 v56, 0xffff0000, v12
    v_lshlrev_b32 v54, 16, v12
    v_rcp_f32 v56, v56
    v_lshlrev_b32 v20, 16, v105
    v_and_b32 v21, 0xffff0000, v105
    v_pk_add_f32 v[58:59], v[20:21], v[54:55] op_sel:[0,0] op_sel_hi:[1,0] neg_lo:[0,1] neg_hi:[0,1]
    v_cvt_pk_bf16_f32 v60, v58, v59
    v_lshlrev_b32 v58, 16, v60
    v_and_b32 v59, 0xffff0000, v60
    v_pk_mul_f32 v[58:59], v[58:59], v[56:57] op_sel:[0,0] op_sel_hi:[1,0]
    v_cvt_pk_bf16_f32 v60, v58, v59
    v_lshlrev_b32 v98, 16, v60
    v_and_b32 v99, 0xffff0000, v60
    v_cvt_pk_f16_f32 v61, v98, v99
    ds_write_b16 v110, v61 offset:1024
    ds_write_b16_d16_hi v110, v61 offset:5632
    v_mul_f32 v58, 0xbfb8aa3b, v96
    v_mul_f32 v59, 0xbfb8aa3b, v97
    v_pk_mul_f32 v[54:55], v[96:97], v[8:9]
    v_exp_f32 v58, v58
    v_exp_f32 v59, v59
    v_cvt_pk_bf16_f32 v56, v54, v55
    v_add_f32 v58, 1.0, v58
    v_add_f32 v59, 1.0, v59
    v_lshlrev_b32 v34, 16, v56
    v_and_b32 v35, 0xffff0000, v56
    v_rcp_f32 v58, v58
    v_rcp_f32 v59, v59
    s_nop 0
    v_pk_mul_f32 v[58:59], v[58:59], v[96:97]
    v_cvt_pk_bf16_f32 v56, v58, v59
    v_lshlrev_b32 v26, 16, v56
    v_and_b32 v27, 0xffff0000, v56
    s_waitcnt lgkmcnt(0)
    s_barrier
    global_load_dword v107, v2, s[96:97]
    ds_read_b64 a[0:1], v62 offset:4032
    ds_read_b64 a[2:3], v62 offset:4040
    ds_read_b128 v[68:71], v4 offset:992
    ds_read_b128 v[64:67], v4 offset:480
    ds_read_b64 a[4:5], v62 offset:3520
    ds_read_b64 a[6:7], v62 offset:3528
    ds_read_b64 a[32:33], v62 offset:3968
    ds_read_b64 a[34:35], v62 offset:3976
    ds_read_b128 a[84:87], v4 offset:928
    ds_read_b128 a[80:83], v4 offset:416
    ds_read_b64 a[36:37], v62 offset:3456
    ds_read_b64 a[38:39], v62 offset:3464
    s_waitcnt lgkmcnt(9)
    v_mfma_f32_16x16x32_f16 a[64:67], a[0:3], v[68:71], 0
    s_waitcnt lgkmcnt(8)
    v_mfma_f32_16x16x32_f16 a[68:71], a[0:3], v[64:67], 0
    v_mul_f32 v58, 0xbfb8aa3b, v98
    v_mul_f32 v59, 0xbfb8aa3b, v99
    v_mul_f32 v54, v98, v8
    v_mul_f32 v55, v99, v9
    s_waitcnt lgkmcnt(6)
    v_mfma_f32_16x16x32_f16 a[64:67], a[4:7], v[64:67], a[64:67]
    v_exp_f32 v58, v58
    v_exp_f32 v59, v59
    v_cvt_pk_bf16_f32 v56, v54, v55
    v_add_f32 v58, 1.0, v58
    ds_read_b64 a[8:9], v62 offset:3008
    ds_read_b64 a[10:11], v62 offset:3016
    ds_read_b64 a[12:13], v62 offset:2496
    s_waitcnt lgkmcnt(6)
    v_mfma_f32_16x16x32_f16 a[64:67], a[32:35], a[84:87], a[64:67]
    v_add_f32 v59, 1.0, v59
    v_lshlrev_b32 v36, 16, v56
    v_and_b32 v37, 0xffff0000, v56
    v_rcp_f32 v58, v58
    ds_read_b64 a[14:15], v62 offset:2504
    ds_read_b64 a[40:41], v62 offset:2944
    ds_read_b64 a[42:43], v62 offset:2952
    s_waitcnt lgkmcnt(8)
    v_mfma_f32_16x16x32_f16 a[68:71], a[32:35], a[80:83], a[68:71]
    v_rcp_f32 v59, v59
    v_mul_f32 v58, v58, v98
    v_mul_f32 v59, v59, v99
    v_cvt_pk_bf16_f32 v56, v58, v59
    ds_read_b64 a[44:45], v62 offset:2432
    ds_read_b64 a[46:47], v62 offset:2440
    ds_read_b128 v[72:75], v4 offset:1504
    s_waitcnt lgkmcnt(9)
    v_mfma_f32_16x16x32_f16 a[64:67], a[36:39], a[80:83], a[64:67]
    v_lshlrev_b32 v28, 16, v56
    v_and_b32 v29, 0xffff0000, v56
    ds_read_b128 v[76:79], v4 offset:2016
    ds_read_b128 a[88:91], v4 offset:1440
    ds_read_b128 a[92:95], v4 offset:1952
    v_mov_b32 v63, 256
    global_load_dwordx4 v[10:13], v63, s[8:9] sc1
    s_cmp_eq_u32 s2, 0
    s_cbranch_scc0 L_now
    s_cmp_eq_u32 s30, 0
    s_cbranch_scc0 L_now
    v_mov_b32 v54, 0
    v_mov_b32 v55, s31
    s_mov_b64 exec, 1
    global_store_dword v54, v55, s[8:9] sc1
    s_mov_b64 exec, -1
    s_waitcnt vmcnt(0)
L_now:
    s_waitcnt lgkmcnt(3)
    v_mfma_f32_16x16x32_f16 a[76:79], a[0:3], v[72:75], 0
    v_mfma_f32_16x16x32_f16 a[76:79], a[4:7], v[68:71], a[76:79]
    s_waitcnt lgkmcnt(2)
    v_mfma_f32_16x16x32_f16 a[72:75], a[0:3], v[76:79], 0
    ds_write_b128 v5, a[68:71] offset:0
    ds_write_b128 v5, a[64:67] offset:1024
    v_mfma_f32_16x16x32_f16 a[76:79], a[8:11], v[64:67], a[76:79]
    v_mfma_f32_16x16x32_f16 a[72:75], a[4:7], v[72:75], a[72:75]
    s_waitcnt lgkmcnt(3)
    v_mfma_f32_16x16x32_f16 a[76:79], a[32:35], a[88:91], a[76:79]
    s_waitcnt lgkmcnt(0)
    s_barrier
    v_mfma_f32_16x16x32_f16 a[72:75], a[8:11], v[68:71], a[72:75]
    ds_read2st64_b32 v[42:43], v3 offset0:0 offset1:64
    v_mfma_f32_16x16x32_f16 a[76:79], a[36:39], a[84:87], a[76:79]
    ds_read2st64_b32 v[44:45], v3 offset0:128 offset1:192
    v_mfma_f32_16x16x32_f16 a[72:75], a[12:15], v[64:67], a[72:75]
    ds_read2st64_b32 v[46:47], v3 offset0:32 offset1:96
    v_mfma_f32_16x16x32_f16 a[76:79], a[40:43], a[80:83], a[76:79]
    ds_read2st64_b32 v[48:49], v3 offset0:160 offset1:224
    ds_read_b64 a[16:17], v62 offset:1984
    ds_read_b64 a[18:19], v62 offset:1992
    v_mfma_f32_16x16x32_f16 a[72:75], a[32:35], a[92:95], a[72:75]
    s_waitcnt lgkmcnt(5)
    v_add_f32 v42, v42, v43
    s_waitcnt lgkmcnt(4)
    v_add_f32 v44, v44, v45
    s_waitcnt lgkmcnt(3)
    v_add_f32 v46, v46, v47
    ds_read_b64 a[20:21], v62 offset:1472
    ds_read_b64 a[22:23], v62 offset:1480
    v_mfma_f32_16x16x32_f16 a[72:75], a[36:39], a[88:91], a[72:75]
    s_waitcnt lgkmcnt(4)
    v_add_f32 v48, v48, v49
    v_add_f32 v42, v42, v44
    v_add_f32 v46, v46, v48
    ds_read_b64 a[48:49], v62 offset:1920
    ds_read_b64 a[50:51], v62 offset:1928
    v_mfma_f32_16x16x32_f16 a[72:75], a[40:43], a[84:87], a[72:75]
    ds_write_b128 v5, a[76:79] offset:2048
    v_cvt_pk_bf16_f32 v52, v42, v46
    v_lshlrev_b32 v50, 16, v52
    v_and_b32 v51, 0xffff0000, v52
    ds_read_b64 a[52:53], v62 offset:1408
    ds_read_b64 a[54:55], v62 offset:1416
    v_mfma_f32_16x16x32_f16 a[72:75], a[44:47], a[80:83], a[72:75]
    v_fma_f32 v50, v50, v6, v34
    v_fma_f32 v51, v51, v7, v35
    v_cvt_pk_bf16_f32 v52, v50, v51
    v_lshlrev_b32 v50, 16, v52
    v_and_b32 v51, 0xffff0000, v52
    v_mul_f32 v50, v50, v26
    v_mul_f32 v51, v51, v27
    v_cvt_pk_bf16_f32 v52, v50, v51
    v_lshlrev_b32 v50, 16, v52
    v_and_b32 v51, 0xffff0000, v52
    v_add_f32 v50, v50, v18
    v_add_f32 v51, v51, v19
    v_cvt_pk_bf16_f32 v53, v50, v51
    global_store_dword v2, v53, s[10:11]
    s_waitcnt vmcnt(3)
    v_and_b32 v56, 0xffff0000, v15
    v_lshlrev_b32 v54, 16, v15
    v_rcp_f32 v56, v56
    v_lshlrev_b32 v22, 16, v106
    v_and_b32 v23, 0xffff0000, v106
    v_sub_f32 v58, v22, v54
    v_sub_f32 v59, v23, v54
    v_cvt_pk_bf16_f32 v60, v58, v59
    v_lshlrev_b32 v58, 16, v60
    v_and_b32 v59, 0xffff0000, v60
    v_mul_f32 v58, v58, v56
    v_mul_f32 v59, v59, v56
    v_cvt_pk_bf16_f32 v60, v58, v59
    v_lshlrev_b32 v100, 16, v60
    v_and_b32 v101, 0xffff0000, v60
    v_cvt_pk_f16_f32 v61, v100, v101
    ds_write_b16 v110, v61 offset:2048
    ds_write_b16_d16_hi v110, v61 offset:6656
    v_mfma_f32_16x16x32_f16 a[68:71], a[4:7], v[76:79], 0
    v_mfma_f32_16x16x32_f16 a[68:71], a[8:11], v[72:75], a[68:71]
    v_mfma_f32_16x16x32_f16 a[64:67], a[8:11], v[76:79], 0
    ds_write_b128 v5, a[72:75] offset:3072
    v_mfma_f32_16x16x32_f16 a[68:71], a[12:15], v[68:71], a[68:71]
    v_mfma_f32_16x16x32_f16 a[64:67], a[12:15], v[72:75], a[64:67]
    s_waitcnt lgkmcnt(10)
    v_mfma_f32_16x16x32_f16 a[68:71], a[16:19], v[64:67], a[68:71]
    s_waitcnt lgkmcnt(0)
    s_barrier
    ds_read_b128 v[80:83], v4 offset:2528
    ds_read_b128 a[96:99], v4 offset:2464
    ds_read_b128 v[84:87], v4 offset:3040
    ds_read_b128 a[100:103], v4 offset:2976
    v_mfma_f32_16x16x32_f16 a[64:67], a[16:19], v[68:71], a[64:67]
    ds_read2st64_b32 v[42:43], v3 offset0:8 offset1:72
    v_mfma_f32_16x16x32_f16 a[68:71], a[36:39], a[92:95], a[68:71]
    ds_read2st64_b32 v[44:45], v3 offset0:136 offset1:200
    v_mfma_f32_16x16x32_f16 a[64:67], a[20:23], v[64:67], a[64:67]
    ds_read2st64_b32 v[46:47], v3 offset0:40 offset1:104
    v_mfma_f32_16x16x32_f16 a[68:71], a[40:43], a[88:91], a[68:71]
    ds_read2st64_b32 v[48:49], v3 offset0:168 offset1:232
    ds_read_b64 a[24:25], v62 offset:960
    v_mfma_f32_16x16x32_f16 a[64:67], a[40:43], a[92:95], a[64:67]
    s_waitcnt lgkmcnt(4)
    v_add_f32 v42, v42, v43
    s_waitcnt lgkmcnt(3)
    v_add_f32 v44, v44, v45
    s_waitcnt lgkmcnt(2)
    v_add_f32 v46, v46, v47
    ds_read_b64 a[26:27], v62 offset:968
    v_mfma_f32_16x16x32_f16 a[68:71], a[44:47], a[84:87], a[68:71]
    s_waitcnt lgkmcnt(2)
    v_add_f32 v48, v48, v49
    v_add_f32 v42, v42, v44
    v_add_f32 v46, v46, v48
    ds_read_b64 a[28:29], v62 offset:448
    v_mfma_f32_16x16x32_f16 a[64:67], a[44:47], a[88:91], a[64:67]
    v_cvt_pk_bf16_f32 v52, v42, v46
    v_lshlrev_b32 v50, 16, v52
    v_and_b32 v51, 0xffff0000, v52
    ds_read_b64 a[30:31], v62 offset:456
    v_mfma_f32_16x16x32_f16 a[68:71], a[48:51], a[80:83], a[68:71]
    v_fma_f32 v50, v50, v6, v36
    v_fma_f32 v51, v51, v7, v37
    v_cvt_pk_bf16_f32 v52, v50, v51
    ds_read_b64 a[56:57], v62 offset:896
    v_mfma_f32_16x16x32_f16 a[64:67], a[48:51], a[84:87], a[64:67]
    v_lshlrev_b32 v50, 16, v52
    v_and_b32 v51, 0xffff0000, v52
    v_mul_f32 v50, v50, v28
    ds_read_b64 a[58:59], v62 offset:904
    v_mfma_f32_16x16x32_f16 a[68:71], a[0:3], v[80:83], a[68:71]
    v_mul_f32 v51, v51, v29
    v_cvt_pk_bf16_f32 v52, v50, v51
    v_lshlrev_b32 v50, 16, v52
    ds_read_b64 a[60:61], v62 offset:384
    v_mfma_f32_16x16x32_f16 a[64:67], a[52:55], a[80:83], a[64:67]
    v_and_b32 v51, 0xffff0000, v52
    v_add_f32 v50, v50, v20
    v_add_f32 v51, v51, v21
    ds_read_b64 a[62:63], v62 offset:392
    v_mfma_f32_16x16x32_f16 a[68:71], a[32:35], a[96:99], a[68:71]
    v_cvt_pk_bf16_f32 v53, v50, v51
    global_store_dword v2, v53, s[62:63]
    s_waitcnt vmcnt(3)
    v_mfma_f32_16x16x32_f16 a[64:67], a[0:3], v[84:87], a[64:67]
    v_and_b32 v56, 0xffff0000, v16
    v_lshlrev_b32 v54, 16, v16
    v_rcp_f32 v56, v56
    v_mfma_f32_16x16x32_f16 a[64:67], a[4:7], v[80:83], a[64:67]
    v_lshlrev_b32 v24, 16, v107
    v_and_b32 v25, 0xffff0000, v107
    v_sub_f32 v58, v24, v54
    v_mfma_f32_16x16x32_f16 a[64:67], a[32:35], a[100:103], a[64:67]
    ds_write_b128 v5, a[68:71] offset:4096
    v_sub_f32 v59, v25, v54
    v_cvt_pk_bf16_f32 v60, v58, v59
    v_lshlrev_b32 v58, 16, v60
    v_mfma_f32_16x16x32_f16 a[64:67], a[36:39], a[96:99], a[64:67]
    v_and_b32 v59, 0xffff0000, v60
    v_mul_f32 v58, v58, v56
    v_mul_f32 v59, v59, v56
    v_cvt_pk_bf16_f32 v60, v58, v59
    v_lshlrev_b32 v102, 16, v60
    v_and_b32 v103, 0xffff0000, v60
    v_cvt_pk_f16_f32 v61, v102, v103
    ds_write_b16 v110, v61 offset:3072
    ds_write_b16_d16_hi v110, v61 offset:7680
    v_mul_f32 v58, 0xbfb8aa3b, v100
    v_mul_f32 v59, 0xbfb8aa3b, v101
    v_mul_f32 v54, v100, v8
    v_mul_f32 v55, v101, v9
    v_exp_f32 v58, v58
    v_exp_f32 v59, v59
    v_cvt_pk_bf16_f32 v56, v54, v55
    v_add_f32 v58, 1.0, v58
    v_add_f32 v59, 1.0, v59
    v_lshlrev_b32 v38, 16, v56
    v_and_b32 v39, 0xffff0000, v56
    v_rcp_f32 v58, v58
    v_rcp_f32 v59, v59
    v_mul_f32 v58, v58, v100
    v_mul_f32 v59, v59, v101
    v_cvt_pk_bf16_f32 v56, v58, v59
    v_lshlrev_b32 v30, 16, v56
    v_and_b32 v31, 0xffff0000, v56
    v_mfma_f32_16x16x32_f16 a[76:79], a[4:7], v[84:87], 0
    v_mfma_f32_16x16x32_f16 a[76:79], a[8:11], v[80:83], a[76:79]
    v_mfma_f32_16x16x32_f16 a[72:75], a[8:11], v[84:87], 0
    ds_write_b128 v5, a[64:67] offset:5120
    v_mfma_f32_16x16x32_f16 a[76:79], a[12:15], v[76:79], a[76:79]
    v_mfma_f32_16x16x32_f16 a[72:75], a[12:15], v[80:83], a[72:75]
    v_mfma_f32_16x16x32_f16 a[76:79], a[16:19], v[72:75], a[76:79]
    s_waitcnt lgkmcnt(0)
    s_barrier
    ds_read_b128 v[88:91], v4 offset:3552
    ds_read_b128 a[104:107], v4 offset:3488
    ds_read_b128 v[92:95], v4 offset:4064
    ds_read_b128 a[108:111], v4 offset:4000
    v_mfma_f32_16x16x32_f16 a[72:75], a[16:19], v[76:79], a[72:75]
    ds_read2st64_b32 v[42:43], v3 offset0:16 offset1:80
    v_mfma_f32_16x16x32_f16 a[76:79], a[20:23], v[68:71], a[76:79]
    ds_read2st64_b32 v[44:45], v3 offset0:144 offset1:208
    v_mfma_f32_16x16x32_f16 a[72:75], a[20:23], v[72:75], a[72:75]
    ds_read2st64_b32 v[46:47], v3 offset0:48 offset1:112
    v_mfma_f32_16x16x32_f16 a[76:79], a[24:27], v[64:67], a[76:79]
    ds_read2st64_b32 v[48:49], v3 offset0:176 offset1:240
    v_mfma_f32_16x16x32_f16 a[72:75], a[24:27], v[68:71], a[72:75]
    s_waitcnt lgkmcnt(3)
    v_add_f32 v42, v42, v43
    s_waitcnt lgkmcnt(2)
    v_add_f32 v44, v44, v45
    v_mfma_f32_16x16x32_f16 a[76:79], a[36:39], a[100:103], a[76:79]
    s_waitcnt lgkmcnt(1)
    v_add_f32 v46, v46, v47
    s_waitcnt lgkmcnt(0)
    v_add_f32 v48, v48, v49
    v_mfma_f32_16x16x32_f16 a[72:75], a[28:31], v[64:67], a[72:75]
    v_add_f32 v42, v42, v44
    v_add_f32 v46, v46, v48
    v_mfma_f32_16x16x32_f16 a[76:79], a[40:43], a[96:99], a[76:79]
    v_cvt_pk_bf16_f32 v52, v42, v46
    v_lshlrev_b32 v50, 16, v52
    v_mfma_f32_16x16x32_f16 a[72:75], a[40:43], a[100:103], a[72:75]
    v_and_b32 v51, 0xffff0000, v52
    v_fma_f32 v50, v50, v6, v38
    v_mfma_f32_16x16x32_f16 a[76:79], a[44:47], a[92:95], a[76:79]
    v_fma_f32 v51, v51, v7, v39
    v_cvt_pk_bf16_f32 v52, v50, v51
    v_mfma_f32_16x16x32_f16 a[72:75], a[44:47], a[96:99], a[72:75]
    v_lshlrev_b32 v50, 16, v52
    v_and_b32 v51, 0xffff0000, v52
    v_mfma_f32_16x16x32_f16 a[76:79], a[48:51], a[88:91], a[76:79]
    v_mul_f32 v50, v50, v30
    v_mul_f32 v51, v51, v31
    v_mfma_f32_16x16x32_f16 a[72:75], a[48:51], a[92:95], a[72:75]
    v_cvt_pk_bf16_f32 v52, v50, v51
    v_lshlrev_b32 v50, 16, v52
    v_mfma_f32_16x16x32_f16 a[76:79], a[52:55], a[84:87], a[76:79]
    v_and_b32 v51, 0xffff0000, v52
    v_add_f32 v50, v50, v22
    v_mfma_f32_16x16x32_f16 a[72:75], a[52:55], a[88:91], a[72:75]
    v_add_f32 v51, v51, v23
    v_cvt_pk_bf16_f32 v53, v50, v51
    v_mfma_f32_16x16x32_f16 a[76:79], a[56:59], a[80:83], a[76:79]
    global_store_dword v2, v53, s[98:99]
    v_mul_f32 v58, 0xbfb8aa3b, v102
    v_mfma_f32_16x16x32_f16 a[72:75], a[56:59], a[84:87], a[72:75]
    v_mul_f32 v59, 0xbfb8aa3b, v103
    v_mul_f32 v54, v102, v8
    v_mfma_f32_16x16x32_f16 a[76:79], a[0:3], v[88:91], a[76:79]
    v_mul_f32 v55, v103, v9
    v_exp_f32 v58, v58
    v_mfma_f32_16x16x32_f16 a[72:75], a[60:63], a[80:83], a[72:75]
    v_exp_f32 v59, v59
    v_cvt_pk_bf16_f32 v56, v54, v55
    v_mfma_f32_16x16x32_f16 a[76:79], a[32:35], a[104:107], a[76:79]
    s_mov_b32 s50, 0
    s_waitcnt vmcnt(3)
    s_nop 5
L_sel_chk:
    v_readfirstlane_b32 s33, v10
    v_readfirstlane_b32 s34, v13
    v_readfirstlane_b32 s46, v11
    v_readfirstlane_b32 s47, v12
    s_cmp_eq_u32 s33, s31
    s_cselect_b32 s33, s34, 0
    s_cmp_eq_u32 s33, s31
    s_cbranch_scc1 L_sel_ok
    s_add_u32 s50, s50, 1
    s_cmp_gt_u32 s50, 65536
    s_cbranch_scc1 L_sel_ok
    global_load_dwordx4 v[10:13], v63, s[8:9] sc1
    s_waitcnt vmcnt(0)
    s_branch L_sel_chk
L_sel_ok:
    s_mov_b64 s[52:53], -1
    s_mov_b32 s35, 0
    s_mov_b32 s36, 0
    s_lshl_b32 s36, s36, 6
    s_and_b32 s48, s46, 0x7ff
    s_sub_u32 s48, 2047, s48
    s_sub_u32 s33, s48, s36
    s_and_b32 s33, s33, 511
    s_lshr_b32 s34, s33, 6
    s_and_b32 s33, s33, 63
    s_lshl_b64 s[38:39], 1, s33
    s_cmp_eq_u32 s34, s30
    s_cselect_b32 s34, 1, 0
    s_or_b32 s35, s35, s34
    s_lshr_b32 s33, s48, 9
    s_cmp_eq_u32 s33, 3
    s_cselect_b32 s34, s34, 0
    s_cmp_lg_u32 s34, 0
    s_cselect_b64 s[38:39], s[38:39], 0
    s_andn2_b64 s[52:53], s[52:53], s[38:39]
    s_and_b32 s49, s47, 0x7ff
    s_sub_u32 s49, 2047, s49
    s_sub_u32 s33, s49, s36
    s_and_b32 s33, s33, 511
    s_lshr_b32 s34, s33, 6
    s_and_b32 s33, s33, 63
    s_lshl_b64 s[38:39], 1, s33
    s_cmp_eq_u32 s34, s30
    s_cselect_b32 s34, 2, 0
    s_or_b32 s35, s35, s34
    s_lshr_b32 s33, s49, 9
    s_cmp_eq_u32 s33, 3
    s_cselect_b32 s34, s34, 0
    s_cmp_lg_u32 s34, 0
    s_cselect_b64 s[38:39], s[38:39], 0
    s_andn2_b64 s[52:53], s[52:53], s[38:39]
    s_cmp_eq_u32 s35, 0
    s_cbranch_scc1 L_noown1
    v_min_u32 v63, 55, v1
    v_mul_u32_u24 v63, 3584, v63
    s_lshl_b32 s33, s32, 4
    s_add_u32 s33, s33, 32768
    v_add_u32 v63, s33, v63
    global_load_dwordx4 v[10:13], v63, s[8:9] sc1
    v_and_b32 v101, 2, v1
    v_cmp_eq_u32 vcc, 0, v101
    v_mov_b32 v101, s48
    v_mov_b32 v104, s49
    v_cndmask_b32 v100, v104, v101, vcc
    v_mov_b32 v101, s46
    v_mov_b32 v104, s47
    v_cndmask_b32 v96, v104, v101, vcc
    v_and_b32 v99, 1, v1
    v_mul_u32_u24 v15, 896, v100
    s_lshl_b32 s34, s32, 2
    v_lshl_add_u32 v15, v99, 1, v15
    v_add_u32 v15, s34, v15
    global_load_ushort v14, v15, s[4:5]
    v_lshrrev_b32 v101, 4, v100
    v_lshlrev_b32 v16, 6, v101
    v_bfe_u32 v101, v100, 2, 2
    v_bfe_u32 v104, v100, 5, 2
    v_xor_b32 v101, v101, v104
    v_lshl_add_u32 v16, v101, 4, v16
    v_and_b32 v101, 3, v100
    v_lshl_add_u32 v16, v101, 2, v16
    v_mul_u32_u24 v101, 8192, v99
    v_mul_u32_u24 v101, 8192, v99
    v_add_u32 v16, v16, v101
    v_add_u32 v16, 33792, v16
    v_mul_u32_u24 v101, 4608, v99
    v_lshl_add_u32 v17, v100, 1, v101
    v_add_u32 v17, 118976, v17
    v_cmp_eq_u32 vcc, 0, v99
    v_lshrrev_b32 v96, 16, v96
    v_bfe_i32 v101, v96, 15, 1
    v_cndmask_b32 v97, v9, v8, vcc
    v_cndmask_b32 v98, v7, v6, vcc
    v_and_b32 v101, 0x7fff, v101
    v_xor_b32 v101, 0xffff, v101
    v_xor_b32 v96, v96, v101
    v_lshlrev_b32 v96, 16, v96
    v_mul_f32 v96, 0xbfb8aa3b, v96
    v_exp_f32 v96, v96
    s_nop 0
    v_add_f32 v96, 1.0, v96
    v_rcp_f32 v96, v96
    s_nop 0
    v_cvt_pk_bf16_f32 v96, v96, v96
    v_lshlrev_b32 v96, 16, v96
    s_bitcmp1_b32 s35, 0
    s_cselect_b32 s40, 3, 0
    s_bitcmp1_b32 s35, 1
    s_cselect_b32 s33, 12, 0
    s_or_b32 s40, s40, s33
    s_mov_b32 s41, 0
L_noown1:
    v_add_f32 v58, 1.0, v58
    v_add_f32 v59, 1.0, v59
    v_mfma_f32_16x16x32_f16 a[72:75], a[0:3], v[92:95], a[72:75]
    v_lshlrev_b32 v40, 16, v56
    v_and_b32 v41, 0xffff0000, v56
    v_mfma_f32_16x16x32_f16 a[72:75], a[4:7], v[88:91], a[72:75]
    v_rcp_f32 v58, v58
    v_rcp_f32 v59, v59
    v_mfma_f32_16x16x32_f16 a[72:75], a[32:35], a[108:111], a[72:75]
    ds_write_b128 v5, a[76:79] offset:6144
    v_mul_f32 v58, v58, v102
    v_mul_f32 v59, v59, v103
    v_mfma_f32_16x16x32_f16 a[72:75], a[36:39], a[104:107], a[72:75]
    v_cvt_pk_bf16_f32 v56, v58, v59
    v_lshlrev_b32 v32, 16, v56
    v_and_b32 v33, 0xffff0000, v56
    s_nop 4
    ds_write_b128 v5, a[72:75] offset:7168
    s_waitcnt lgkmcnt(0)
    s_barrier
    ds_read2st64_b32 v[42:43], v3 offset0:24 offset1:88
    ds_read2st64_b32 v[44:45], v3 offset0:152 offset1:216
    ds_read2st64_b32 v[46:47], v3 offset0:56 offset1:120
    ds_read2st64_b32 v[48:49], v3 offset0:184 offset1:248
    s_waitcnt lgkmcnt(3)
    v_add_f32 v42, v42, v43
    s_waitcnt lgkmcnt(2)
    v_add_f32 v44, v44, v45
    s_waitcnt lgkmcnt(1)
    v_add_f32 v46, v46, v47
    s_waitcnt lgkmcnt(0)
    v_add_f32 v48, v48, v49
    v_add_f32 v42, v42, v44
    v_add_f32 v46, v46, v48
    v_cvt_pk_bf16_f32 v52, v42, v46
    v_lshlrev_b32 v50, 16, v52
    v_and_b32 v51, 0xffff0000, v52
    v_fma_f32 v50, v50, v6, v40
    v_fma_f32 v51, v51, v7, v41
    v_cvt_pk_bf16_f32 v52, v50, v51
    v_lshlrev_b32 v50, 16, v52
    v_and_b32 v51, 0xffff0000, v52
    v_pk_mul_f32 v[50:51], v[50:51], v[32:33]
    v_cvt_pk_bf16_f32 v52, v50, v51
    v_lshlrev_b32 v50, 16, v52
    v_and_b32 v51, 0xffff0000, v52
    v_pk_add_f32 v[50:51], v[50:51], v[24:25]
    v_cvt_pk_bf16_f32 v53, v50, v51
    s_mov_b64 exec, s[52:53]
    global_store_dword v2, v53, s[100:101]
    s_mov_b64 exec, -1
    s_cmp_eq_u32 s35, 0
    s_cbranch_scc1 L_conv_end
    ds_read_b32 v66, v16 offset:0
    ds_read_b32 v67, v16 offset:16384
    ds_read_b32 v68, v16 offset:32768
    ds_read_b32 v69, v16 offset:49152
    ds_read_u16 v70, v17
    s_mov_b32 s50, 0
    s_mov_b32 s52, 0x0c0c0400
    s_mov_b32 s53, 0x04000c0c
    s_waitcnt lgkmcnt(3)
    v_add_f32 v66, v66, v67
    s_waitcnt lgkmcnt(1)
    v_add_f32 v68, v68, v69
    s_waitcnt lgkmcnt(0)
    v_cvt_f32_f16 v70, v70
    v_add_f32 v66, v66, v68
    v_mul_f32 v73, v70, v97
    v_cvt_pk_bf16_f32 v66, v66, v66
    v_lshlrev_b32 v66, 16, v66
    v_cvt_pk_bf16_f32 v73, v73, v73
    v_lshlrev_b32 v73, 16, v73
    v_fma_f32 v71, v66, v98, v73
    v_cvt_pk_bf16_f32 v71, v71, v71
    v_lshlrev_b32 v71, 16, v71
    s_waitcnt vmcnt(1)
    s_nop 0
L_yp_chk:
    v_perm_b32 v64, v11, v10, s52
    v_perm_b32 v65, v13, v12, s53
    v_or_b32 v64, v64, v65
    v_cmp_ne_u32 vcc, s31, v64
    s_cbranch_vccz L_yp_ok
    s_add_u32 s50, s50, 1
    s_cmp_gt_u32 s50, 65536
    s_cbranch_scc1 L_yp_ok
    global_load_dwordx4 v[10:13], v63, s[8:9] sc1
    s_waitcnt vmcnt(0)
    s_branch L_yp_chk
L_yp_ok:
    s_mov_b32 exec_lo, 0
    s_mov_b32 exec_hi, 0xff000000
    v_mov_b32 v10, 0
    v_mov_b32 v11, 0
    v_mov_b32 v12, 0
    v_mov_b32 v13, 0
    s_mov_b64 exec, -1
    v_and_b32 v10, 0xffffff00, v10
    v_and_b32 v11, 0xffffff00, v11
    v_and_b32 v12, 0xffffff00, v12
    v_and_b32 v13, 0xffffff00, v13
    v_add_f32_dpp v10, v10, v10 row_shr:1 row_mask:0xf bank_mask:0xf bound_ctrl:0
    v_add_f32_dpp v11, v11, v11 row_shr:1 row_mask:0xf bank_mask:0xf bound_ctrl:0
    v_add_f32_dpp v12, v12, v12 row_shr:1 row_mask:0xf bank_mask:0xf bound_ctrl:0
    v_add_f32_dpp v13, v13, v13 row_shr:1 row_mask:0xf bank_mask:0xf bound_ctrl:0
    v_add_f32_dpp v10, v10, v10 row_shr:2 row_mask:0xf bank_mask:0xf bound_ctrl:0
    v_add_f32_dpp v11, v11, v11 row_shr:2 row_mask:0xf bank_mask:0xf bound_ctrl:0
    v_add_f32_dpp v12, v12, v12 row_shr:2 row_mask:0xf bank_mask:0xf bound_ctrl:0
    v_add_f32_dpp v13, v13, v13 row_shr:2 row_mask:0xf bank_mask:0xf bound_ctrl:0
    v_add_f32_dpp v10, v10, v10 row_shr:4 row_mask:0xf bank_mask:0xf bound_ctrl:0
    v_add_f32_dpp v11, v11, v11 row_shr:4 row_mask:0xf bank_mask:0xf bound_ctrl:0
    v_add_f32_dpp v12, v12, v12 row_shr:4 row_mask:0xf bank_mask:0xf bound_ctrl:0
    v_add_f32_dpp v13, v13, v13 row_shr:4 row_mask:0xf bank_mask:0xf bound_ctrl:0
    v_add_f32_dpp v10, v10, v10 row_shr:8 row_mask:0xf bank_mask:0xf bound_ctrl:0
    v_add_f32_dpp v11, v11, v11 row_shr:8 row_mask:0xf bank_mask:0xf bound_ctrl:0
    v_add_f32_dpp v12, v12, v12 row_shr:8 row_mask:0xf bank_mask:0xf bound_ctrl:0
    v_add_f32_dpp v13, v13, v13 row_shr:8 row_mask:0xf bank_mask:0xf bound_ctrl:0
    v_add_f32_dpp v10, v10, v10 row_bcast:15 row_mask:0xa bank_mask:0xf
    v_add_f32_dpp v11, v11, v11 row_bcast:15 row_mask:0xa bank_mask:0xf
    v_add_f32_dpp v12, v12, v12 row_bcast:15 row_mask:0xa bank_mask:0xf
    v_add_f32_dpp v13, v13, v13 row_bcast:15 row_mask:0xa bank_mask:0xf
    v_add_f32_dpp v10, v10, v10 row_bcast:31 row_mask:0xc bank_mask:0xf
    v_add_f32_dpp v11, v11, v11 row_bcast:31 row_mask:0xc bank_mask:0xf
    v_add_f32_dpp v12, v12, v12 row_bcast:31 row_mask:0xc bank_mask:0xf
    v_add_f32_dpp v13, v13, v13 row_bcast:31 row_mask:0xc bank_mask:0xf
    v_readlane_b32 s54, v10, 63
    v_readlane_b32 s55, v11, 63
    v_readlane_b32 s56, v12, 63
    v_readlane_b32 s57, v13, 63
    v_lshlrev_b32 v14, 16, v14
    v_writelane_b32 v72, s54, 0
    v_writelane_b32 v72, s55, 1
    v_writelane_b32 v72, s56, 2
    v_writelane_b32 v72, s57, 3
    v_cvt_pk_bf16_f32 v72, v72, v72
    v_lshlrev_b32 v72, 16, v72
    v_mul_f32 v72, v72, v96
    v_cvt_pk_bf16_f32 v72, v72, v72
    v_lshlrev_b32 v72, 16, v72
    v_add_f32 v72, v70, v72
    v_cvt_pk_bf16_f32 v72, v72, v72
    v_lshlrev_b32 v72, 16, v72
    v_mul_f32 v73, 0xbfb8aa3b, v72
    v_exp_f32 v73, v73
    s_nop 0
    v_add_f32 v73, 1.0, v73
    v_rcp_f32 v73, v73
    s_nop 0
    v_mul_f32 v72, v72, v73
    v_cvt_pk_bf16_f32 v72, v72, v72
    v_lshlrev_b32 v72, 16, v72
    v_mul_f32 v72, v71, v72
    v_cvt_pk_bf16_f32 v72, v72, v72
    v_lshlrev_b32 v72, 16, v72
    v_add_f32 v72, v14, v72
    v_cvt_pk_bf16_f32 v72, v72, v72
    s_mov_b64 exec, s[40:41]
    global_store_short v15, v72, s[10:11]
    s_mov_b64 exec, -1
L_conv_end:
    s_endpgm
L_ffn:
    s_sub_u32 s33, s51, 28
    s_lshl_b32 s33, s33, 3
    s_and_b32 s34, s2, 7
    s_add_u32 s32, s33, s34
    s_waitcnt lgkmcnt(0)
    s_load_dword s31, s[8:9], 0
    s_cmp_ge_u32 s32, 28
    s_cbranch_scc1 L_ffn_idle
    s_and_b32 s35, s30, 3
    s_lshr_b32 s37, s30, 2
    s_cmp_ge_u32 s30, 4
    s_cbranch_scc1 L_f_load
    s_add_u32 s38, s4, s49
    s_addc_u32 s39, s5, 0
    s_mov_b32 exec_hi, 0x00ffffff
    global_load_dwordx4 v[64:67], v76, s[38:39]
    s_add_u32 s40, s38, 458752
    s_addc_u32 s41, s39, 0
    global_load_dwordx4 v[68:71], v76, s[40:41]
    global_load_dwordx4 v[72:75], v76, s[6:7]
    s_mov_b32 exec_hi, -1
    v_mov_b32 v62, 0x3b124925
    v_cmp_gt_u32 vcc, 56, v1
    s_nop 1
    v_cndmask_b32 v60, 0, 1.0, vcc
    v_mov_b32 v61, v60
    s_lshr_b32 s33, s30, 1
    s_lshl_b32 s33, s33, 13
    s_lshl_b32 s34, s2, 5
    s_add_u32 s33, s33, s34
    s_and_b32 s34, s30, 1
    s_lshl_b32 s34, s34, 4
    s_add_u32 s33, s33, s34
    s_add_u32 s33, s33, 4096
    v_mov_b32 v63, s33
    s_waitcnt vmcnt(0) lgkmcnt(0)
    s_add_u32 s31, s31, 0x9e3779b9
    v_lshlrev_b32 v42, 16, v72
    v_and_b32 v43, 0xffff0000, v72
    v_lshlrev_b32 v44, 16, v73
    v_and_b32 v45, 0xffff0000, v73
    v_lshlrev_b32 v46, 16, v74
    v_and_b32 v47, 0xffff0000, v74
    v_lshlrev_b32 v48, 16, v75
    v_and_b32 v49, 0xffff0000, v75
    v_lshlrev_b32 v26, 16, v64
    v_lshlrev_b32 v27, 16, v68
    v_and_b32 v28, 0xffff0000, v64
    v_and_b32 v29, 0xffff0000, v68
    v_lshlrev_b32 v30, 16, v65
    v_lshlrev_b32 v31, 16, v69
    v_and_b32 v32, 0xffff0000, v65
    v_and_b32 v33, 0xffff0000, v69
    v_lshlrev_b32 v34, 16, v66
    v_lshlrev_b32 v35, 16, v70
    v_and_b32 v36, 0xffff0000, v66
    v_and_b32 v37, 0xffff0000, v70
    v_lshlrev_b32 v38, 16, v67
    v_lshlrev_b32 v39, 16, v71
    v_and_b32 v40, 0xffff0000, v67
    v_and_b32 v41, 0xffff0000, v71
    v_pk_add_f32 v[50:51], v[26:27], v[28:29]
    v_pk_mul_f32 v[52:53], v[26:27], v[42:43] op_sel:[0,0] op_sel_hi:[1,0]
    v_pk_add_f32 v[54:55], v[42:43], v[44:45]
    v_pk_fma_f32 v[52:53], v[42:43], v[28:29], v[52:53] op_sel:[1,0,0] op_sel_hi:[1,1,1]
    v_pk_add_f32 v[50:51], v[50:51], v[30:31]
    v_pk_fma_f32 v[52:53], v[30:31], v[44:45], v[52:53] op_sel:[0,0,0] op_sel_hi:[1,0,1]
    v_pk_add_f32 v[50:51], v[50:51], v[32:33]
    v_pk_fma_f32 v[52:53], v[44:45], v[32:33], v[52:53] op_sel:[1,0,0] op_sel_hi:[1,1,1]
    v_pk_add_f32 v[50:51], v[50:51], v[34:35]
    v_pk_fma_f32 v[52:53], v[34:35], v[46:47], v[52:53] op_sel:[0,0,0] op_sel_hi:[1,0,1]
    v_pk_add_f32 v[50:51], v[50:51], v[36:37]
    v_pk_fma_f32 v[52:53], v[46:47], v[36:37], v[52:53] op_sel:[1,0,0] op_sel_hi:[1,1,1]
    v_pk_add_f32 v[50:51], v[50:51], v[38:39]
    v_pk_fma_f32 v[52:53], v[38:39], v[48:49], v[52:53] op_sel:[0,0,0] op_sel_hi:[1,0,1]
    v_pk_add_f32 v[50:51], v[50:51], v[40:41]
    v_pk_fma_f32 v[52:53], v[48:49], v[40:41], v[52:53] op_sel:[1,0,0] op_sel_hi:[1,1,1]
    v_pk_add_f32 v[54:55], v[54:55], v[46:47]
    v_pk_add_f32 v[54:55], v[54:55], v[48:49]
    v_add_f32 v54, v54, v55
    v_add_f32_dpp v50, v50, v50 row_shr:1 row_mask:0xf bank_mask:0xf bound_ctrl:0
    v_add_f32_dpp v51, v51, v51 row_shr:1 row_mask:0xf bank_mask:0xf bound_ctrl:0
    v_add_f32_dpp v52, v52, v52 row_shr:1 row_mask:0xf bank_mask:0xf bound_ctrl:0
    v_add_f32_dpp v53, v53, v53 row_shr:1 row_mask:0xf bank_mask:0xf bound_ctrl:0
    v_add_f32_dpp v54, v54, v54 row_shr:1 row_mask:0xf bank_mask:0xf bound_ctrl:0
    v_add_f32_dpp v50, v50, v50 row_shr:2 row_mask:0xf bank_mask:0xf bound_ctrl:0
    v_add_f32_dpp v51, v51, v51 row_shr:2 row_mask:0xf bank_mask:0xf bound_ctrl:0
    v_add_f32_dpp v52, v52, v52 row_shr:2 row_mask:0xf bank_mask:0xf bound_ctrl:0
    v_add_f32_dpp v53, v53, v53 row_shr:2 row_mask:0xf bank_mask:0xf bound_ctrl:0
    v_add_f32_dpp v54, v54, v54 row_shr:2 row_mask:0xf bank_mask:0xf bound_ctrl:0
    v_add_f32_dpp v50, v50, v50 row_shr:4 row_mask:0xf bank_mask:0xf bound_ctrl:0
    v_add_f32_dpp v51, v51, v51 row_shr:4 row_mask:0xf bank_mask:0xf bound_ctrl:0
    v_add_f32_dpp v52, v52, v52 row_shr:4 row_mask:0xf bank_mask:0xf bound_ctrl:0
    v_add_f32_dpp v53, v53, v53 row_shr:4 row_mask:0xf bank_mask:0xf bound_ctrl:0
    v_add_f32_dpp v54, v54, v54 row_shr:4 row_mask:0xf bank_mask:0xf bound_ctrl:0
    v_add_f32_dpp v50, v50, v50 row_shr:8 row_mask:0xf bank_mask:0xf bound_ctrl:0
    v_add_f32_dpp v51, v51, v51 row_shr:8 row_mask:0xf bank_mask:0xf bound_ctrl:0
    v_add_f32_dpp v52, v52, v52 row_shr:8 row_mask:0xf bank_mask:0xf bound_ctrl:0
    v_add_f32_dpp v53, v53, v53 row_shr:8 row_mask:0xf bank_mask:0xf bound_ctrl:0
    v_add_f32_dpp v54, v54, v54 row_shr:8 row_mask:0xf bank_mask:0xf bound_ctrl:0
    v_add_f32_dpp v50, v50, v50 row_bcast:15 row_mask:0xa bank_mask:0xf
    v_add_f32_dpp v51, v51, v51 row_bcast:15 row_mask:0xa bank_mask:0xf
    v_add_f32_dpp v52, v52, v52 row_bcast:15 row_mask:0xa bank_mask:0xf
    v_add_f32_dpp v53, v53, v53 row_bcast:15 row_mask:0xa bank_mask:0xf
    v_add_f32_dpp v54, v54, v54 row_bcast:15 row_mask:0xa bank_mask:0xf
    v_add_f32_dpp v50, v50, v50 row_bcast:31 row_mask:0xc bank_mask:0xf
    v_add_f32_dpp v51, v51, v51 row_bcast:31 row_mask:0xc bank_mask:0xf
    v_add_f32_dpp v52, v52, v52 row_bcast:31 row_mask:0xc bank_mask:0xf
    v_add_f32_dpp v53, v53, v53 row_bcast:31 row_mask:0xc bank_mask:0xf
    v_add_f32_dpp v54, v54, v54 row_bcast:31 row_mask:0xc bank_mask:0xf
    v_readlane_b32 s52, v50, 63
    v_readlane_b32 s53, v51, 63
    s_nop 0
    v_mul_f32 v56, s52, v62
    v_mul_f32 v57, s53, v62
    v_pk_add_f32 v[26:27], v[26:27], v[56:57] neg_lo:[0,1] neg_hi:[0,1]
    v_pk_add_f32 v[28:29], v[28:29], v[56:57] neg_lo:[0,1] neg_hi:[0,1]
    v_pk_add_f32 v[30:31], v[30:31], v[56:57] neg_lo:[0,1] neg_hi:[0,1]
    v_pk_add_f32 v[32:33], v[32:33], v[56:57] neg_lo:[0,1] neg_hi:[0,1]
    v_pk_add_f32 v[34:35], v[34:35], v[56:57] neg_lo:[0,1] neg_hi:[0,1]
    v_pk_add_f32 v[36:37], v[36:37], v[56:57] neg_lo:[0,1] neg_hi:[0,1]
    v_pk_add_f32 v[38:39], v[38:39], v[56:57] neg_lo:[0,1] neg_hi:[0,1]
    v_pk_add_f32 v[40:41], v[40:41], v[56:57] neg_lo:[0,1] neg_hi:[0,1]
    v_pk_mul_f32 v[58:59], v[26:27], v[26:27]
    v_pk_fma_f32 v[58:59], v[28:29], v[28:29], v[58:59]
    v_pk_fma_f32 v[58:59], v[30:31], v[30:31], v[58:59]
    v_pk_fma_f32 v[58:59], v[32:33], v[32:33], v[58:59]
    v_pk_fma_f32 v[58:59], v[34:35], v[34:35], v[58:59]
    v_pk_fma_f32 v[58:59], v[36:37], v[36:37], v[58:59]
    v_pk_fma_f32 v[58:59], v[38:39], v[38:39], v[58:59]
    v_pk_fma_f32 v[58:59], v[40:41], v[40:41], v[58:59]
    v_pk_mul_f32 v[58:59], v[58:59], v[60:61]
    s_nop 1
    v_add_f32_dpp v58, v58, v58 row_shr:1 row_mask:0xf bank_mask:0xf bound_ctrl:0
    v_add_f32_dpp v59, v59, v59 row_shr:1 row_mask:0xf bank_mask:0xf bound_ctrl:0
    s_nop 0
    v_add_f32_dpp v58, v58, v58 row_shr:2 row_mask:0xf bank_mask:0xf bound_ctrl:0
    v_add_f32_dpp v59, v59, v59 row_shr:2 row_mask:0xf bank_mask:0xf bound_ctrl:0
    s_nop 0
    v_add_f32_dpp v58, v58, v58 row_shr:4 row_mask:0xf bank_mask:0xf bound_ctrl:0
    v_add_f32_dpp v59, v59, v59 row_shr:4 row_mask:0xf bank_mask:0xf bound_ctrl:0
    s_nop 0
    v_add_f32_dpp v58, v58, v58 row_shr:8 row_mask:0xf bank_mask:0xf bound_ctrl:0
    v_add_f32_dpp v59, v59, v59 row_shr:8 row_mask:0xf bank_mask:0xf bound_ctrl:0
    s_nop 0
    v_add_f32_dpp v58, v58, v58 row_bcast:15 row_mask:0xa bank_mask:0xf
    v_add_f32_dpp v59, v59, v59 row_bcast:15 row_mask:0xa bank_mask:0xf
    s_nop 0
    v_add_f32_dpp v58, v58, v58 row_bcast:31 row_mask:0xc bank_mask:0xf
    v_add_f32_dpp v59, v59, v59 row_bcast:31 row_mask:0xc bank_mask:0xf
    v_readlane_b32 s54, v58, 63
    v_readlane_b32 s55, v59, 63
    v_cvt_pk_bf16_f32 v82, v56, v57
    v_mul_f32 v80, s54, v62
    v_mul_f32 v81, s55, v62
    v_cvt_pk_bf16_f32 v83, v80, v81
    v_lshlrev_b32 v84, 16, v82
    v_and_b32 v85, 0xffff0000, v82
    v_lshlrev_b32 v80, 16, v83
    v_and_b32 v81, 0xffff0000, v83
    v_add_f32 v80, 0x3727c5ac, v80
    v_add_f32 v81, 0x3727c5ac, v81
    v_cvt_pk_bf16_f32 v83, v80, v81
    v_lshlrev_b32 v80, 16, v83
    v_and_b32 v81, 0xffff0000, v83
    v_sqrt_f32 v80, v80
    v_sqrt_f32 v81, v81
    v_fma_f32 v52, -v84, v54, v52
    v_fma_f32 v53, -v85, v54, v53
    v_cvt_pk_bf16_f32 v83, v80, v81
    s_mov_b32 s33, 0x05040100
    s_mov_b32 s34, 0x07060302
    v_lshlrev_b32 v80, 16, v83
    v_and_b32 v81, 0xffff0000, v83
    v_rcp_f32 v80, v80
    v_rcp_f32 v81, v81
    v_perm_b32 v77, v83, v82, s33
    v_perm_b32 v78, v83, v82, s34
    v_mov_b32 v76, s31
    v_mul_f32 v52, v52, v80
    v_mul_f32 v53, v53, v81
    v_cvt_pk_bf16_f32 v79, v52, v53
    s_mov_b32 exec_lo, 0
    s_mov_b32 exec_hi, 0x80000000
    global_store_dwordx4 v63, v[76:79], s[8:9] sc1
    s_mov_b64 exec, -1
    s_and_b32 s35, s30, 3
    v_lshrrev_b32 v2, 3, v1
    v_mul_u32_u24 v25, 3584, v2
    v_and_b32 v3, 2, v2
    s_and_b32 s33, s30, 1
    s_lshl_b32 s33, s33, 2
    v_or_b32 v3, s33, v3
    v_and_b32 v4, 7, v1
    v_xor_b32 v4, v4, v3
    v_lshl_add_u32 v25, v4, 4, v25
    s_add_u32 s36, s35, 40
    s_lshl_b32 s33, s32, 7
    s_mul_i32 s34, s36, 28672
    s_add_u32 s33, s33, s34
    s_add_u32 s38, s24, s33
    s_addc_u32 s39, s25, 0
    s_add_u32 s40, s26, s33
    s_addc_u32 s41, s27, 0
    s_lshl_b32 s46, s36, 10
    s_mov_b32 m0, s46
    s_add_u32 s47, s46, 57344
    global_load_lds_dwordx4 v25, s[38:39]
    s_mov_b32 m0, s47
    s_add_u32 s46, s46, 4096
    global_load_lds_dwordx4 v25, s[40:41]
    s_add_u32 s38, s38, 114688
    s_addc_u32 s39, s39, 0
    s_add_u32 s40, s40, 114688
    s_addc_u32 s41, s41, 0
    s_mov_b32 m0, s46
    s_add_u32 s47, s46, 57344
    global_load_lds_dwordx4 v25, s[38:39]
    s_mov_b32 m0, s47
    s_add_u32 s46, s46, 4096
    global_load_lds_dwordx4 v25, s[40:41]
    s_add_u32 s38, s38, 114688
    s_addc_u32 s39, s39, 0
    s_add_u32 s40, s40, 114688
    s_addc_u32 s41, s41, 0
    s_mov_b32 m0, s46
    s_add_u32 s47, s46, 57344
    global_load_lds_dwordx4 v25, s[38:39]
    s_mov_b32 m0, s47
    s_add_u32 s46, s46, 4096
    global_load_lds_dwordx4 v25, s[40:41]
    s_add_u32 s38, s38, 114688
    s_addc_u32 s39, s39, 0
    s_add_u32 s40, s40, 114688
    s_addc_u32 s41, s41, 0
    s_mov_b32 m0, s46
    s_add_u32 s47, s46, 57344
    global_load_lds_dwordx4 v25, s[38:39]
    s_mov_b32 m0, s47
    s_add_u32 s46, s46, 4096
    global_load_lds_dwordx4 v25, s[40:41]
    s_and_b32 s35, s30, 3
    v_lshrrev_b32 v2, 4, v1
    v_bfe_u32 v3, v1, 2, 2
    v_and_b32 v4, 1, v2
    v_lshlrev_b32 v4, 2, v4
    v_and_or_b32 v4, v3, 2, v4
    v_lshl_add_u32 v2, v2, 3, v3
    v_bfe_u32 v3, v1, 1, 1
    s_lshl_b32 s33, s35, 1
    v_add_u32 v5, s33, v3
    v_xor_b32 v5, v5, v4
    v_lshlrev_b32 v6, 7, v2
    v_lshl_add_u32 v6, v5, 4, v6
    v_and_b32 v5, 1, v1
    v_lshl_add_u32 v6, v5, 3, v6
    s_mul_i32 s34, s37, 28672
    v_add_u32 v6, s34, v6
    v_add_u32 v7, 57344, v6
    v_mul_u32_u24 v8, 896, v2
    v_lshl_add_u32 v8, v5, 3, v8
    s_mul_i32 s34, s37, 28672
    v_add_u32 v8, s34, v8
    s_mul_i32 s33, s35, 14
    v_add_u32 v18, s33, v3
    v_add_u32 v18, 0, v18
    v_xor_b32 v18, v18, v4
    v_lshl_add_u32 v18, v18, 4, v8
    v_add_u32 v19, s33, v3
    v_add_u32 v19, 2, v19
    v_xor_b32 v19, v19, v4
    v_lshl_add_u32 v19, v19, 4, v8
    v_add_u32 v20, s33, v3
    v_add_u32 v20, 4, v20
    v_xor_b32 v20, v20, v4
    v_lshl_add_u32 v20, v20, 4, v8
    v_add_u32 v21, s33, v3
    v_add_u32 v21, 6, v21
    v_xor_b32 v21, v21, v4
    v_lshl_add_u32 v21, v21, 4, v8
    v_add_u32 v22, s33, v3
    v_add_u32 v22, 8, v22
    v_xor_b32 v22, v22, v4
    v_lshl_add_u32 v22, v22, 4, v8
    v_add_u32 v23, s33, v3
    v_add_u32 v23, 10, v23
    v_xor_b32 v23, v23, v4
    v_lshl_add_u32 v23, v23, 4, v8
    v_add_u32 v24, s33, v3
    v_add_u32 v24, 12, v24
    v_xor_b32 v24, v24, v4
    v_lshl_add_u32 v24, v24, 4, v8
    v_and_b32 v2, 1, v1
    v_mul_u32_u24 v9, 896, v2
    v_lshrrev_b32 v5, 4, v1
    v_lshl_add_u32 v9, v5, 4, v9
    s_mul_i32 s33, s37, 448
    s_add_u32 s33, s33, 122880
    v_add_u32 v9, s33, v9
    v_lshlrev_b32 v12, 7, v2
    v_lshl_add_u32 v12, v5, 4, v12
    s_lshl_b32 s33, s37, 6
    s_add_u32 s33, s33, 125696
    v_add_u32 v12, s33, v12
    s_lshl_b32 s33, s35, 8
    s_add_u32 s33, s33, 124672
    v_and_b32 v10, 15, v1
    v_lshlrev_b32 v10, 4, v10
    v_add_u32 v10, s33, v10
    s_lshl_b32 s33, s35, 5
    s_add_u32 s33, s33, 125696
    v_lshlrev_b32 v11, 1, v1
    v_add_u32 v11, s33, v11
    s_bfe_u32 s33, s31, 0x00080000
    v_mov_b32 v14, s33
    s_bfe_u32 s33, s31, 0x00080008
    v_mov_b32 v15, s33
    s_bfe_u32 s33, s31, 0x00080010
    v_mov_b32 v16, s33
    s_bfe_u32 s33, s31, 0x00080018
    v_mov_b32 v17, s33
    s_lshl_b32 s33, s32, 1
    s_add_u32 s33, s33, s37
    s_mul_i32 s33, s33, 3584
    s_mul_i32 s34, s35, 896
    s_add_u32 s33, s33, s34
    s_add_u32 s33, s33, 32768
    v_lshrrev_b32 v13, 1, v1
    v_lshlrev_b32 v13, 4, v13
    v_add_u32 v13, s33, v13
    v_lshlrev_b32 v25, 5, v0
    v_add_u32 v25, 4096, v25
    v_add_u32 v42, 8192, v25
    global_load_dwordx4 v[26:29], v25, s[8:9] offset:0 sc1
    global_load_dwordx4 v[30:33], v25, s[8:9] offset:16 sc1
    global_load_dwordx4 v[34:37], v42, s[8:9] offset:0 sc1
    global_load_dwordx4 v[38:41], v42, s[8:9] offset:16 sc1
    s_mov_b32 s50, 0
    s_waitcnt vmcnt(0)
L_frec_chk:
    v_cmp_ne_u32 vcc, s31, v26
    v_cmp_ne_u32 s[38:39], s31, v30
    s_nop 0
    s_or_b64 vcc, vcc, s[38:39]
    v_cmp_ne_u32 s[38:39], s31, v34
    s_nop 0
    s_or_b64 vcc, vcc, s[38:39]
    v_cmp_ne_u32 s[38:39], s31, v38
    s_nop 0
    s_or_b64 vcc, vcc, s[38:39]
    s_cbranch_vccz L_frec_ok
    s_add_u32 s50, s50, 1
    s_cmp_gt_u32 s50, 65536
    s_cbranch_scc1 L_frec_ok
    global_load_dwordx4 v[26:29], v25, s[8:9] offset:0 sc1
    global_load_dwordx4 v[30:33], v25, s[8:9] offset:16 sc1
    global_load_dwordx4 v[34:37], v42, s[8:9] offset:0 sc1
    global_load_dwordx4 v[38:41], v42, s[8:9] offset:16 sc1
    s_waitcnt vmcnt(0)
    s_branch L_frec_chk
L_frec_ok:
    v_lshlrev_b32 v25, 3, v0
    v_add_u32 v25, 114688, v25
    v_add_u32 v42, 4096, v25
    ds_write2_b32 v25, v27, v31 offset0:0 offset1:1
    ds_write2_b32 v42, v35, v39 offset0:0 offset1:1
    v_add_u32 v25, 2048, v25
    v_add_u32 v42, 2048, v42
    ds_write2_b32 v25, v28, v32 offset0:0 offset1:1
    ds_write2_b32 v42, v36, v40 offset0:0 offset1:1
    v_lshlrev_b32 v51, 1, v0
    v_sub_u32 v51, 2047, v51
    s_mov_b32 s33, 0xffff0000
    s_lshl_b32 s34, s30, 3
    s_add_u32 s34, s34, 125952
    v_mov_b32 v56, s34
    v_pk_ashrrev_i16 v52, 15, v29 op_sel_hi:[0,1]
    v_subrev_u32 v53, 0, v51
    v_or_b32 v52, 0x80008000, v52
    v_subrev_u32 v57, 512, v51
    v_xor_b32 v52, v52, v29
    v_lshl_or_b32 v43, v52, 16, v53
    v_and_or_b32 v44, v52, s33, v57
    v_pk_ashrrev_i16 v52, 15, v33 op_sel_hi:[0,1]
    v_subrev_u32 v53, 1, v51
    v_or_b32 v52, 0x80008000, v52
    v_subrev_u32 v57, 513, v51
    v_xor_b32 v52, v52, v33
    v_lshl_or_b32 v45, v52, 16, v53
    v_and_or_b32 v46, v52, s33, v57
    v_pk_ashrrev_i16 v52, 15, v37 op_sel_hi:[0,1]
    v_subrev_u32 v53, 1024, v51
    v_or_b32 v52, 0x80008000, v52
    v_subrev_u32 v57, 1536, v51
    v_xor_b32 v52, v52, v37
    v_lshl_or_b32 v47, v52, 16, v53
    v_and_or_b32 v48, v52, s33, v57
    v_pk_ashrrev_i16 v52, 15, v41 op_sel_hi:[0,1]
    v_subrev_u32 v53, 1025, v51
    v_or_b32 v52, 0x80008000, v52
    v_subrev_u32 v57, 1537, v51
    v_xor_b32 v52, v52, v41
    v_lshl_or_b32 v49, v52, 16, v53
    v_and_or_b32 v50, v52, s33, v57
    v_max_u32 v54, v43, v44
    v_min_u32 v55, v43, v44
    v_med3_u32 v55, v54, v55, v45
    v_max_u32 v54, v54, v45
    v_med3_u32 v55, v54, v55, v46
    v_max_u32 v54, v54, v46
    v_med3_u32 v55, v54, v55, v47
    v_max_u32 v54, v54, v47
    v_med3_u32 v55, v54, v55, v48
    v_max_u32 v54, v54, v48
    v_med3_u32 v55, v54, v55, v49
    v_max_u32 v54, v54, v49
    v_med3_u32 v55, v54, v55, v50
    v_max_u32 v54, v54, v50
    s_nop 0
    v_max_u32_dpp v53, v55, v55 row_shr:1 row_mask:0xf bank_mask:0xf bound_ctrl:0
    v_min_u32_dpp v52, v54, v54 row_shr:1 row_mask:0xf bank_mask:0xf bound_ctrl:0
    v_max_u32_dpp v54, v54, v54 row_shr:1 row_mask:0xf bank_mask:0xf bound_ctrl:0
    v_max_u32 v55, v52, v53
    s_nop 1
    v_max_u32_dpp v53, v55, v55 row_shr:2 row_mask:0xf bank_mask:0xf bound_ctrl:0
    v_min_u32_dpp v52, v54, v54 row_shr:2 row_mask:0xf bank_mask:0xf bound_ctrl:0
    v_max_u32_dpp v54, v54, v54 row_shr:2 row_mask:0xf bank_mask:0xf bound_ctrl:0
    v_max_u32 v55, v52, v53
    s_nop 1
    v_max_u32_dpp v53, v55, v55 row_shr:4 row_mask:0xf bank_mask:0xf bound_ctrl:0
    v_min_u32_dpp v52, v54, v54 row_shr:4 row_mask:0xf bank_mask:0xf bound_ctrl:0
    v_max_u32_dpp v54, v54, v54 row_shr:4 row_mask:0xf bank_mask:0xf bound_ctrl:0
    v_max_u32 v55, v52, v53
    s_nop 1
    v_max_u32_dpp v53, v55, v55 row_shr:8 row_mask:0xf bank_mask:0xf bound_ctrl:0
    v_min_u32_dpp v52, v54, v54 row_shr:8 row_mask:0xf bank_mask:0xf bound_ctrl:0
    v_max_u32_dpp v54, v54, v54 row_shr:8 row_mask:0xf bank_mask:0xf bound_ctrl:0
    v_max_u32 v55, v52, v53
    s_nop 1
    v_max_u32_dpp v53, v55, v55 row_bcast:15 row_mask:0xa bank_mask:0xf
    v_min_u32_dpp v52, v54, v54 row_bcast:15 row_mask:0xa bank_mask:0xf
    v_max_u32_dpp v54, v54, v54 row_bcast:15 row_mask:0xa bank_mask:0xf
    v_max_u32 v55, v52, v53
    s_nop 1
    v_max_u32_dpp v53, v55, v55 row_bcast:31 row_mask:0xc bank_mask:0xf
    v_min_u32_dpp v52, v54, v54 row_bcast:31 row_mask:0xc bank_mask:0xf
    v_max_u32_dpp v54, v54, v54 row_bcast:31 row_mask:0xc bank_mask:0xf
    v_max_u32 v55, v52, v53
    s_mov_b32 exec_lo, 0
    s_mov_b32 exec_hi, 0x80000000
    ds_write_b64 v56, v[54:55]
    s_mov_b64 exec, -1
    s_waitcnt lgkmcnt(0)
    s_barrier
    v_and_b32 v25, 3, v1
    v_lshlrev_b32 v25, 3, v25
    v_add_u32 v25, 125952, v25
    ds_read_b64 v[28:29], v25
    s_waitcnt lgkmcnt(0)
    v_max_u32_dpp v27, v29, v29 row_shr:1 row_mask:0xf bank_mask:0xf bound_ctrl:0
    v_min_u32_dpp v26, v28, v28 row_shr:1 row_mask:0xf bank_mask:0xf bound_ctrl:0
    v_max_u32_dpp v28, v28, v28 row_shr:1 row_mask:0xf bank_mask:0xf bound_ctrl:0
    v_max_u32 v29, v26, v27
    s_nop 1
    v_max_u32_dpp v27, v29, v29 row_shr:2 row_mask:0xf bank_mask:0xf bound_ctrl:0
    v_min_u32_dpp v26, v28, v28 row_shr:2 row_mask:0xf bank_mask:0xf bound_ctrl:0
    v_max_u32_dpp v28, v28, v28 row_shr:2 row_mask:0xf bank_mask:0xf bound_ctrl:0
    v_max_u32 v29, v26, v27
    v_readlane_b32 s46, v28, 3
    v_readlane_b32 s47, v29, 3
    s_and_b32 s48, s46, 0x7ff
    s_and_b32 s49, s47, 0x7ff
    s_sub_u32 s48, 2047, s48
    s_sub_u32 s49, 2047, s49
    v_min_u32 v25, 111, v0
    v_cmp_le_u32 vcc, 56, v25
    v_mov_b32 v40, s48
    v_mov_b32 v41, s49
    v_subrev_u32 v42, 56, v25
    v_cndmask_b32 v40, v40, v41, vcc
    v_cndmask_b32 v42, v25, v42, vcc
    v_mul_u32_u24 v43, 896, v40
    v_lshl_add_u32 v43, v42, 4, v43
    global_load_dwordx4 v[26:29], v43, s[4:5]
    v_lshlrev_b32 v40, 2, v40
    v_add_u32 v40, 114688, v40
    ds_read_b32 v30, v40
    v_lshlrev_b32 v31, 4, v25
    v_add_u32 v31, 122880, v31
    s_waitcnt lgkmcnt(0)
    v_lshlrev_b32 v40, 16, v30
    v_and_b32 v42, 0xffff0000, v30
    v_rcp_f32 v42, v42
    s_waitcnt vmcnt(0)
    v_lshlrev_b32 v32, 16, v26
    v_and_b32 v33, 0xffff0000, v26
    v_lshlrev_b32 v34, 16, v27
    v_and_b32 v35, 0xffff0000, v27
    v_lshlrev_b32 v36, 16, v28
    v_and_b32 v37, 0xffff0000, v28
    v_lshlrev_b32 v38, 16, v29
    v_and_b32 v39, 0xffff0000, v29
    v_pk_add_f32 v[32:33], v[32:33], v[40:41] op_sel:[0,0] op_sel_hi:[1,0] neg_lo:[0,1] neg_hi:[0,1]
    v_pk_add_f32 v[34:35], v[34:35], v[40:41] op_sel:[0,0] op_sel_hi:[1,0] neg_lo:[0,1] neg_hi:[0,1]
    v_pk_add_f32 v[36:37], v[36:37], v[40:41] op_sel:[0,0] op_sel_hi:[1,0] neg_lo:[0,1] neg_hi:[0,1]
    v_pk_add_f32 v[38:39], v[38:39], v[40:41] op_sel:[0,0] op_sel_hi:[1,0] neg_lo:[0,1] neg_hi:[0,1]
    v_cvt_pk_bf16_f32 v26, v32, v33
    v_cvt_pk_bf16_f32 v27, v34, v35
    v_cvt_pk_bf16_f32 v28, v36, v37
    v_cvt_pk_bf16_f32 v29, v38, v39
    v_lshlrev_b32 v32, 16, v26
    v_and_b32 v33, 0xffff0000, v26
    v_lshlrev_b32 v34, 16, v27
    v_and_b32 v35, 0xffff0000, v27
    v_lshlrev_b32 v36, 16, v28
    v_and_b32 v37, 0xffff0000, v28
    v_lshlrev_b32 v38, 16, v29
    v_and_b32 v39, 0xffff0000, v29
    v_pk_mul_f32 v[32:33], v[32:33], v[42:43] op_sel:[0,0] op_sel_hi:[1,0]
    v_pk_mul_f32 v[34:35], v[34:35], v[42:43] op_sel:[0,0] op_sel_hi:[1,0]
    v_pk_mul_f32 v[36:37], v[36:37], v[42:43] op_sel:[0,0] op_sel_hi:[1,0]
    v_pk_mul_f32 v[38:39], v[38:39], v[42:43] op_sel:[0,0] op_sel_hi:[1,0]
    v_cvt_pk_bf16_f32 v26, v32, v33
    v_cvt_pk_bf16_f32 v27, v34, v35
    v_cvt_pk_bf16_f32 v28, v36, v37
    v_cvt_pk_bf16_f32 v29, v38, v39
    ds_write_b128 v31, v[26:29]
    s_waitcnt lgkmcnt(0)
    s_branch L_f_join
L_f_load:
    s_and_b32 s35, s30, 3
    v_lshrrev_b32 v2, 3, v1
    v_mul_u32_u24 v25, 3584, v2
    v_and_b32 v3, 2, v2
    s_and_b32 s33, s30, 1
    s_lshl_b32 s33, s33, 2
    v_or_b32 v3, s33, v3
    v_and_b32 v4, 7, v1
    v_xor_b32 v4, v4, v3
    v_lshl_add_u32 v25, v4, 4, v25
    s_add_u32 s36, s35, 0
    s_lshl_b32 s33, s32, 7
    s_mul_i32 s34, s36, 28672
    s_add_u32 s33, s33, s34
    s_add_u32 s38, s24, s33
    s_addc_u32 s39, s25, 0
    s_add_u32 s40, s26, s33
    s_addc_u32 s41, s27, 0
    s_lshl_b32 s46, s36, 10
    s_mov_b32 m0, s46
    s_add_u32 s47, s46, 57344
    global_load_lds_dwordx4 v25, s[38:39]
    s_mov_b32 m0, s47
    s_add_u32 s46, s46, 4096
    global_load_lds_dwordx4 v25, s[40:41]
    s_add_u32 s38, s38, 114688
    s_addc_u32 s39, s39, 0
    s_add_u32 s40, s40, 114688
    s_addc_u32 s41, s41, 0
    s_mov_b32 m0, s46
    s_add_u32 s47, s46, 57344
    global_load_lds_dwordx4 v25, s[38:39]
    s_mov_b32 m0, s47
    s_add_u32 s46, s46, 4096
    global_load_lds_dwordx4 v25, s[40:41]
    s_add_u32 s38, s38, 114688
    s_addc_u32 s39, s39, 0
    s_add_u32 s40, s40, 114688
    s_addc_u32 s41, s41, 0
    s_mov_b32 m0, s46
    s_add_u32 s47, s46, 57344
    global_load_lds_dwordx4 v25, s[38:39]
    s_mov_b32 m0, s47
    s_add_u32 s46, s46, 4096
    global_load_lds_dwordx4 v25, s[40:41]
    s_add_u32 s38, s38, 114688
    s_addc_u32 s39, s39, 0
    s_add_u32 s40, s40, 114688
    s_addc_u32 s41, s41, 0
    s_mov_b32 m0, s46
    s_add_u32 s47, s46, 57344
    global_load_lds_dwordx4 v25, s[38:39]
    s_mov_b32 m0, s47
    s_add_u32 s46, s46, 4096
    global_load_lds_dwordx4 v25, s[40:41]
    s_add_u32 s38, s38, 114688
    s_addc_u32 s39, s39, 0
    s_add_u32 s40, s40, 114688
    s_addc_u32 s41, s41, 0
    s_mov_b32 m0, s46
    s_add_u32 s47, s46, 57344
    global_load_lds_dwordx4 v25, s[38:39]
    s_mov_b32 m0, s47
    s_add_u32 s46, s46, 4096
    global_load_lds_dwordx4 v25, s[40:41]
    s_add_u32 s38, s38, 114688
    s_addc_u32 s39, s39, 0
    s_add_u32 s40, s40, 114688
    s_addc_u32 s41, s41, 0
    s_mov_b32 m0, s46
    s_add_u32 s47, s46, 57344
    global_load_lds_dwordx4 v25, s[38:39]
    s_mov_b32 m0, s47
    s_add_u32 s46, s46, 4096
    global_load_lds_dwordx4 v25, s[40:41]
    s_add_u32 s38, s38, 114688
    s_addc_u32 s39, s39, 0
    s_add_u32 s40, s40, 114688
    s_addc_u32 s41, s41, 0
    s_mov_b32 m0, s46
    s_add_u32 s47, s46, 57344
    global_load_lds_dwordx4 v25, s[38:39]
    s_mov_b32 m0, s47
    s_add_u32 s46, s46, 4096
    global_load_lds_dwordx4 v25, s[40:41]
    s_add_u32 s38, s38, 114688
    s_addc_u32 s39, s39, 0
    s_add_u32 s40, s40, 114688
    s_addc_u32 s41, s41, 0
    s_mov_b32 m0, s46
    s_add_u32 s47, s46, 57344
    global_load_lds_dwordx4 v25, s[38:39]
    s_mov_b32 m0, s47
    s_add_u32 s46, s46, 4096
    global_load_lds_dwordx4 v25, s[40:41]
    s_add_u32 s38, s38, 114688
    s_addc_u32 s39, s39, 0
    s_add_u32 s40, s40, 114688
    s_addc_u32 s41, s41, 0
    s_mov_b32 m0, s46
    s_add_u32 s47, s46, 57344
    global_load_lds_dwordx4 v25, s[38:39]
    s_mov_b32 m0, s47
    s_add_u32 s46, s46, 4096
    global_load_lds_dwordx4 v25, s[40:41]
    s_add_u32 s38, s38, 114688
    s_addc_u32 s39, s39, 0
    s_add_u32 s40, s40, 114688
    s_addc_u32 s41, s41, 0
    s_mov_b32 m0, s46
    s_add_u32 s47, s46, 57344
    global_load_lds_dwordx4 v25, s[38:39]
    s_mov_b32 m0, s47
    s_add_u32 s46, s46, 4096
    global_load_lds_dwordx4 v25, s[40:41]
    v_and_b32 v2, 255, v0
    v_lshrrev_b32 v3, 3, v2
    v_and_b32 v2, 7, v2
    v_mul_u32_u24 v27, 896, v3
    v_mov_b32 v26, v27
    v_lshl_add_u32 v27, v2, 4, v27
    v_and_b32 v4, 2, v3
    v_bfe_u32 v5, v3, 3, 1
    v_lshl_or_b32 v4, v5, 2, v4
    v_xor_b32 v2, v2, v4
    v_lshl_add_u32 v26, v2, 4, v26
    s_mul_i32 s33, s32, 57344
    s_add_u32 s38, s28, s33
    s_addc_u32 s39, s29, 0
    s_add_u32 s40, s38, 28672
    s_addc_u32 s41, s39, 0
    global_load_dwordx4 a[84:87], v27, s[38:39] offset:0
    global_load_dwordx4 a[88:91], v27, s[38:39] offset:128
    global_load_dwordx4 a[92:95], v27, s[38:39] offset:256
    global_load_dwordx4 a[96:99], v27, s[38:39] offset:384
    global_load_dwordx4 a[100:103], v27, s[38:39] offset:512
    global_load_dwordx4 a[104:107], v27, s[38:39] offset:640
    global_load_dwordx4 a[108:111], v27, s[38:39] offset:768
    global_load_dwordx4 a[112:115], v27, s[40:41] offset:0
    global_load_dwordx4 a[116:119], v27, s[40:41] offset:128
    global_load_dwordx4 a[120:123], v27, s[40:41] offset:256
    global_load_dwordx4 a[124:127], v27, s[40:41] offset:384
    global_load_dwordx4 v[116:119], v27, s[40:41] offset:512
    global_load_dwordx4 v[120:123], v27, s[40:41] offset:640
    global_load_dwordx4 v[124:127], v27, s[40:41] offset:768
    s_waitcnt lgkmcnt(0)
    s_add_u32 s31, s31, 0x9e3779b9
    s_and_b32 s35, s30, 3
    v_lshrrev_b32 v2, 4, v1
    v_bfe_u32 v3, v1, 2, 2
    v_and_b32 v4, 1, v2
    v_lshlrev_b32 v4, 2, v4
    v_and_or_b32 v4, v3, 2, v4
    v_lshl_add_u32 v2, v2, 3, v3
    v_bfe_u32 v3, v1, 1, 1
    s_lshl_b32 s33, s35, 1
    v_add_u32 v5, s33, v3
    v_xor_b32 v5, v5, v4
    v_lshlrev_b32 v6, 7, v2
    v_lshl_add_u32 v6, v5, 4, v6
    v_and_b32 v5, 1, v1
    v_lshl_add_u32 v6, v5, 3, v6
    s_mul_i32 s34, s37, 28672
    v_add_u32 v6, s34, v6
    v_add_u32 v7, 57344, v6
    v_mul_u32_u24 v8, 896, v2
    v_lshl_add_u32 v8, v5, 3, v8
    s_mul_i32 s34, s37, 28672
    v_add_u32 v8, s34, v8
    s_mul_i32 s33, s35, 14
    v_add_u32 v18, s33, v3
    v_add_u32 v18, 0, v18
    v_xor_b32 v18, v18, v4
    v_lshl_add_u32 v18, v18, 4, v8
    v_add_u32 v19, s33, v3
    v_add_u32 v19, 2, v19
    v_xor_b32 v19, v19, v4
    v_lshl_add_u32 v19, v19, 4, v8
    v_add_u32 v20, s33, v3
    v_add_u32 v20, 4, v20
    v_xor_b32 v20, v20, v4
    v_lshl_add_u32 v20, v20, 4, v8
    v_add_u32 v21, s33, v3
    v_add_u32 v21, 6, v21
    v_xor_b32 v21, v21, v4
    v_lshl_add_u32 v21, v21, 4, v8
    v_add_u32 v22, s33, v3
    v_add_u32 v22, 8, v22
    v_xor_b32 v22, v22, v4
    v_lshl_add_u32 v22, v22, 4, v8
    v_add_u32 v23, s33, v3
    v_add_u32 v23, 10, v23
    v_xor_b32 v23, v23, v4
    v_lshl_add_u32 v23, v23, 4, v8
    v_add_u32 v24, s33, v3
    v_add_u32 v24, 12, v24
    v_xor_b32 v24, v24, v4
    v_lshl_add_u32 v24, v24, 4, v8
    v_and_b32 v2, 1, v1
    v_mul_u32_u24 v9, 896, v2
    v_lshrrev_b32 v5, 4, v1
    v_lshl_add_u32 v9, v5, 4, v9
    s_mul_i32 s33, s37, 448
    s_add_u32 s33, s33, 122880
    v_add_u32 v9, s33, v9
    v_lshlrev_b32 v12, 7, v2
    v_lshl_add_u32 v12, v5, 4, v12
    s_lshl_b32 s33, s37, 6
    s_add_u32 s33, s33, 125696
    v_add_u32 v12, s33, v12
    s_lshl_b32 s33, s35, 8
    s_add_u32 s33, s33, 124672
    v_and_b32 v10, 15, v1
    v_lshlrev_b32 v10, 4, v10
    v_add_u32 v10, s33, v10
    s_lshl_b32 s33, s35, 5
    s_add_u32 s33, s33, 125696
    v_lshlrev_b32 v11, 1, v1
    v_add_u32 v11, s33, v11
    s_bfe_u32 s33, s31, 0x00080000
    v_mov_b32 v14, s33
    s_bfe_u32 s33, s31, 0x00080008
    v_mov_b32 v15, s33
    s_bfe_u32 s33, s31, 0x00080010
    v_mov_b32 v16, s33
    s_bfe_u32 s33, s31, 0x00080018
    v_mov_b32 v17, s33
    s_lshl_b32 s33, s32, 1
    s_add_u32 s33, s33, s37
    s_mul_i32 s33, s33, 3584
    s_mul_i32 s34, s35, 896
    s_add_u32 s33, s33, s34
    s_add_u32 s33, s33, 32768
    v_lshrrev_b32 v13, 1, v1
    v_lshlrev_b32 v13, 4, v13
    v_add_u32 v13, s33, v13
    s_barrier
    s_waitcnt vmcnt(14)
L_f_join:
    s_barrier
    ds_read_b128 v[28:31], v9 offset:0
    ds_read_b64_tr_b16 a[0:1], v6 offset:0
    ds_read_b64_tr_b16 a[2:3], v6 offset:512
    ds_read_b64_tr_b16 a[28:29], v7 offset:0
    ds_read_b64_tr_b16 a[30:31], v7 offset:512
    ds_read_b128 v[32:35], v9 offset:64
    ds_read_b64_tr_b16 a[4:5], v6 offset:4096
    ds_read_b64_tr_b16 a[6:7], v6 offset:4608
    ds_read_b64_tr_b16 a[32:33], v7 offset:4096
    ds_read_b64_tr_b16 a[34:35], v7 offset:4608
    ds_read_b128 v[36:39], v9 offset:128
    ds_read_b64_tr_b16 a[8:9], v6 offset:8192
    ds_read_b64_tr_b16 a[10:11], v6 offset:8704
    ds_read_b64_tr_b16 a[36:37], v7 offset:8192
    ds_read_b64_tr_b16 a[38:39], v7 offset:8704
    s_waitcnt lgkmcnt(12)
    v_mfma_f32_16x16x32_bf16 v[56:59], v[28:31], a[0:3], 0
    s_waitcnt lgkmcnt(10)
    v_mfma_f32_16x16x32_bf16 v[60:63], v[28:31], a[28:31], 0
    ds_read_b128 v[40:43], v9 offset:192
    ds_read_b64_tr_b16 a[12:13], v6 offset:12288
    ds_read_b64_tr_b16 a[14:15], v6 offset:12800
    ds_read_b64_tr_b16 a[40:41], v7 offset:12288
    ds_read_b64_tr_b16 a[42:43], v7 offset:12800
    s_waitcnt lgkmcnt(12)
    v_mfma_f32_16x16x32_bf16 v[56:59], v[32:35], a[4:7], v[56:59]
    s_waitcnt lgkmcnt(10)
    v_mfma_f32_16x16x32_bf16 v[60:63], v[32:35], a[32:35], v[60:63]
    ds_read_b128 v[44:47], v9 offset:256
    ds_read_b64_tr_b16 a[16:17], v6 offset:16384
    ds_read_b64_tr_b16 a[18:19], v6 offset:16896
    ds_read_b64_tr_b16 a[44:45], v7 offset:16384
    ds_read_b64_tr_b16 a[46:47], v7 offset:16896
    s_waitcnt lgkmcnt(12)
    v_mfma_f32_16x16x32_bf16 v[56:59], v[36:39], a[8:11], v[56:59]
    s_waitcnt lgkmcnt(10)
    v_mfma_f32_16x16x32_bf16 v[60:63], v[36:39], a[36:39], v[60:63]
    ds_read_b128 v[48:51], v9 offset:320
    ds_read_b64_tr_b16 a[20:21], v6 offset:20480
    ds_read_b64_tr_b16 a[22:23], v6 offset:20992
    ds_read_b64_tr_b16 a[48:49], v7 offset:20480
    ds_read_b64_tr_b16 a[50:51], v7 offset:20992
    s_waitcnt lgkmcnt(12)
    v_mfma_f32_16x16x32_bf16 v[56:59], v[40:43], a[12:15], v[56:59]
    s_waitcnt lgkmcnt(10)
    v_mfma_f32_16x16x32_bf16 v[60:63], v[40:43], a[40:43], v[60:63]
    ds_read_b128 v[52:55], v9 offset:384
    ds_read_b64_tr_b16 a[24:25], v6 offset:24576
    ds_read_b64_tr_b16 a[26:27], v6 offset:25088
    ds_read_b64_tr_b16 a[52:53], v7 offset:24576
    ds_read_b64_tr_b16 a[54:55], v7 offset:25088
    s_waitcnt lgkmcnt(12)
    v_mfma_f32_16x16x32_bf16 v[56:59], v[44:47], a[16:19], v[56:59]
    s_waitcnt lgkmcnt(10)
    v_mfma_f32_16x16x32_bf16 v[60:63], v[44:47], a[44:47], v[60:63]
    s_waitcnt lgkmcnt(7)
    v_mfma_f32_16x16x32_bf16 v[56:59], v[48:51], a[20:23], v[56:59]
    s_waitcnt lgkmcnt(5)
    v_mfma_f32_16x16x32_bf16 v[60:63], v[48:51], a[48:51], v[60:63]
    s_waitcnt lgkmcnt(2)
    v_mfma_f32_16x16x32_bf16 v[56:59], v[52:55], a[24:27], v[56:59]
    s_waitcnt lgkmcnt(0)
    v_mfma_f32_16x16x32_bf16 v[60:63], v[52:55], a[52:55], v[60:63]
    s_cmp_eq_u32 s37, 0
    s_cbranch_scc1 L_f_kh0
    s_nop 3
    v_mov_b32 v64, v56
    v_mov_b32 v65, v57
    v_mov_b32 v66, v60
    v_mov_b32 v67, v61
    s_mov_b64 exec, 0xffff
    ds_write_b128 v10, v[64:67]
    s_mov_b64 exec, -1
    s_waitcnt vmcnt(0) lgkmcnt(0)
    s_barrier
    ds_write_b128 v26, a[84:87] offset:0
    ds_write_b128 v26, a[88:91] offset:128
    ds_write_b128 v26, a[92:95] offset:256
    ds_write_b128 v26, a[96:99] offset:384
    ds_write_b128 v26, a[100:103] offset:512
    ds_write_b128 v26, a[104:107] offset:640
    ds_write_b128 v26, a[108:111] offset:768
    ds_write_b128 v26, a[112:115] offset:28672
    ds_write_b128 v26, a[116:119] offset:28800
    ds_write_b128 v26, a[120:123] offset:28928
    ds_write_b128 v26, a[124:127] offset:29056
    ds_write_b128 v26, v[116:119] offset:29184
    ds_write_b128 v26, v[120:123] offset:29312
    ds_write_b128 v26, v[124:127] offset:29440
    s_waitcnt lgkmcnt(0)
    s_branch L_f_hjoin
    s_nop 5
L_f_kh0:
    s_waitcnt lgkmcnt(0)
    s_barrier
    ds_read_b128 v[64:67], v10
    s_waitcnt lgkmcnt(0)
    v_pk_add_f32 v[56:57], v[56:57], v[64:65]
    v_pk_add_f32 v[60:61], v[60:61], v[66:67]
    v_cvt_pk_bf16_f32 v68, v56, v57
    v_cvt_pk_bf16_f32 v69, v60, v61
    v_lshlrev_b32 v56, 16, v68
    v_and_b32 v57, 0xffff0000, v68
    v_mul_f32 v70, 0xbfb8aa3b, v56
    v_mul_f32 v71, 0xbfb8aa3b, v57
    v_exp_f32 v70, v70
    v_exp_f32 v71, v71
    v_lshlrev_b32 v60, 16, v69
    v_and_b32 v61, 0xffff0000, v69
    v_add_f32 v70, 1.0, v70
    v_add_f32 v71, 1.0, v71
    v_rcp_f32 v70, v70
    v_rcp_f32 v71, v71
    s_nop 0
    v_pk_mul_f32 v[70:71], v[70:71], v[56:57]
    v_cvt_pk_bf16_f32 v68, v70, v71
    v_lshlrev_b32 v70, 16, v68
    v_and_b32 v71, 0xffff0000, v68
    v_pk_mul_f32 v[70:71], v[70:71], v[60:61]
    v_cvt_pk_bf16_f32 v68, v70, v71
    s_mov_b64 exec, 0xffff
    ds_write_b16 v11, v68
    ds_write_b16_d16_hi v11, v68 offset:128
    s_mov_b64 exec, -1
    s_waitcnt lgkmcnt(0)
L_f_hjoin:
    s_barrier
    ds_read_b128 v[74:77], v12
    ds_read_b64_tr_b16 a[56:57], v18 offset:0
    ds_read_b64_tr_b16 a[58:59], v18 offset:3584
    ds_read_b64_tr_b16 a[60:61], v19 offset:0
    ds_read_b64_tr_b16 a[62:63], v19 offset:3584
    ds_read_b64_tr_b16 a[64:65], v20 offset:0
    ds_read_b64_tr_b16 a[66:67], v20 offset:3584
    ds_read_b64_tr_b16 a[68:69], v21 offset:0
    ds_read_b64_tr_b16 a[70:71], v21 offset:3584
    ds_read_b64_tr_b16 a[72:73], v22 offset:0
    ds_read_b64_tr_b16 a[74:75], v22 offset:3584
    ds_read_b64_tr_b16 a[76:77], v23 offset:0
    ds_read_b64_tr_b16 a[78:79], v23 offset:3584
    ds_read_b64_tr_b16 a[80:81], v24 offset:0
    ds_read_b64_tr_b16 a[82:83], v24 offset:3584
    s_mov_b32 s34, 0xffffff00
    s_waitcnt lgkmcnt(12)
    v_mfma_f32_16x16x32_bf16 v[28:31], v[74:77], a[56:59], 0
    s_waitcnt lgkmcnt(10)
    v_mfma_f32_16x16x32_bf16 v[32:35], v[74:77], a[60:63], 0
    s_waitcnt lgkmcnt(8)
    v_mfma_f32_16x16x32_bf16 v[36:39], v[74:77], a[64:67], 0
    s_waitcnt lgkmcnt(6)
    v_mfma_f32_16x16x32_bf16 v[40:43], v[74:77], a[68:71], 0
    s_waitcnt lgkmcnt(4)
    v_mfma_f32_16x16x32_bf16 v[44:47], v[74:77], a[72:75], 0
    s_waitcnt lgkmcnt(2)
    v_mfma_f32_16x16x32_bf16 v[48:51], v[74:77], a[76:79], 0
    s_waitcnt lgkmcnt(0)
    v_mfma_f32_16x16x32_bf16 v[52:55], v[74:77], a[80:83], 0
    s_mov_b32 exec_lo, 0xffff
    s_mov_b32 exec_hi, 0
    v_mov_b32 v86, v28
    v_mov_b32 v87, v29
    s_mov_b32 exec_lo, 0xffff0000
    s_mov_b32 exec_hi, 0
    v_mov_b32 v86, v32
    v_mov_b32 v87, v33
    s_mov_b32 exec_lo, 0
    s_mov_b32 exec_hi, 0xffff
    v_mov_b32 v86, v36
    v_mov_b32 v87, v37
    s_mov_b32 exec_lo, 0
    s_mov_b32 exec_hi, 0xffff0000
    v_mov_b32 v86, v40
    v_mov_b32 v87, v41
    s_mov_b64 exec, -1
    v_mov_b32_dpp v79, v86 quad_perm:[1,0,3,2] row_mask:0xf bank_mask:0xf
    v_mov_b32_dpp v81, v87 quad_perm:[1,0,3,2] row_mask:0xf bank_mask:0xf
    v_and_or_b32 v78, v86, s34, v14
    v_and_or_b32 v80, v87, s34, v16
    v_and_or_b32 v79, v79, s34, v15
    v_and_or_b32 v81, v81, s34, v17
    s_mov_b32 exec_lo, 0x55555555
    s_mov_b32 exec_hi, 0x55555555
    global_store_dwordx4 v13, v[78:81], s[8:9] offset:0 sc1
    s_mov_b64 exec, -1
    s_mov_b32 exec_lo, 0xffff
    s_mov_b32 exec_hi, 0
    v_mov_b32 v86, v44
    v_mov_b32 v87, v45
    s_mov_b32 exec_lo, 0xffff0000
    s_mov_b32 exec_hi, 0
    v_mov_b32 v86, v48
    v_mov_b32 v87, v49
    s_mov_b32 exec_lo, 0
    s_mov_b32 exec_hi, 0xffff
    v_mov_b32 v86, v52
    v_mov_b32 v87, v53
    s_mov_b64 exec, -1
    v_mov_b32_dpp v83, v86 quad_perm:[1,0,3,2] row_mask:0xf bank_mask:0xf
    v_mov_b32_dpp v85, v87 quad_perm:[1,0,3,2] row_mask:0xf bank_mask:0xf
    v_and_or_b32 v82, v86, s34, v14
    v_and_or_b32 v84, v87, s34, v16
    v_and_or_b32 v83, v83, s34, v15
    v_and_or_b32 v85, v85, s34, v17
    s_mov_b32 exec_lo, 0x55555555
    s_mov_b32 exec_hi, 0x5555
    global_store_dwordx4 v13, v[82:85], s[8:9] offset:512 sc1
    s_mov_b64 exec, -1
    s_endpgm
L_ffn_idle:
    s_cmp_ge_u32 s30, 4
    s_cbranch_scc1 L_end
    s_add_u32 s38, s4, s49
    s_addc_u32 s39, s5, 0
    s_mov_b32 exec_hi, 0x00ffffff
    global_load_dwordx4 v[64:67], v76, s[38:39]
    s_add_u32 s40, s38, 458752
    s_addc_u32 s41, s39, 0
    global_load_dwordx4 v[68:71], v76, s[40:41]
    global_load_dwordx4 v[72:75], v76, s[6:7]
    s_mov_b32 exec_hi, -1
    v_mov_b32 v38, 0x3b124925
    v_cmp_gt_u32 vcc, 56, v1
    s_nop 1
    v_cndmask_b32 v36, 0, 1.0, vcc
    v_mov_b32 v37, v36
    s_lshr_b32 s33, s30, 1
    s_lshl_b32 s33, s33, 13
    s_lshl_b32 s34, s2, 5
    s_add_u32 s33, s33, s34
    s_and_b32 s34, s30, 1
    s_lshl_b32 s34, s34, 4
    s_add_u32 s33, s33, s34
    s_add_u32 s33, s33, 4096
    v_mov_b32 v39, s33
    s_waitcnt vmcnt(0) lgkmcnt(0)
    s_add_u32 s31, s31, 0x9e3779b9
    v_lshlrev_b32 v18, 16, v72
    v_and_b32 v19, 0xffff0000, v72
    v_lshlrev_b32 v20, 16, v73
    v_and_b32 v21, 0xffff0000, v73
    v_lshlrev_b32 v22, 16, v74
    v_and_b32 v23, 0xffff0000, v74
    v_lshlrev_b32 v24, 16, v75
    v_and_b32 v25, 0xffff0000, v75
    v_lshlrev_b32 v2, 16, v64
    v_lshlrev_b32 v3, 16, v68
    v_and_b32 v4, 0xffff0000, v64
    v_and_b32 v5, 0xffff0000, v68
    v_lshlrev_b32 v6, 16, v65
    v_lshlrev_b32 v7, 16, v69
    v_and_b32 v8, 0xffff0000, v65
    v_and_b32 v9, 0xffff0000, v69
    v_lshlrev_b32 v10, 16, v66
    v_lshlrev_b32 v11, 16, v70
    v_and_b32 v12, 0xffff0000, v66
    v_and_b32 v13, 0xffff0000, v70
    v_lshlrev_b32 v14, 16, v67
    v_lshlrev_b32 v15, 16, v71
    v_and_b32 v16, 0xffff0000, v67
    v_and_b32 v17, 0xffff0000, v71
    v_pk_add_f32 v[26:27], v[2:3], v[4:5]
    v_pk_mul_f32 v[28:29], v[2:3], v[18:19] op_sel:[0,0] op_sel_hi:[1,0]
    v_pk_add_f32 v[30:31], v[18:19], v[20:21]
    v_pk_fma_f32 v[28:29], v[18:19], v[4:5], v[28:29] op_sel:[1,0,0] op_sel_hi:[1,1,1]
    v_pk_add_f32 v[26:27], v[26:27], v[6:7]
    v_pk_fma_f32 v[28:29], v[6:7], v[20:21], v[28:29] op_sel:[0,0,0] op_sel_hi:[1,0,1]
    v_pk_add_f32 v[26:27], v[26:27], v[8:9]
    v_pk_fma_f32 v[28:29], v[20:21], v[8:9], v[28:29] op_sel:[1,0,0] op_sel_hi:[1,1,1]
    v_pk_add_f32 v[26:27], v[26:27], v[10:11]
    v_pk_fma_f32 v[28:29], v[10:11], v[22:23], v[28:29] op_sel:[0,0,0] op_sel_hi:[1,0,1]
    v_pk_add_f32 v[26:27], v[26:27], v[12:13]
    v_pk_fma_f32 v[28:29], v[22:23], v[12:13], v[28:29] op_sel:[1,0,0] op_sel_hi:[1,1,1]
    v_pk_add_f32 v[26:27], v[26:27], v[14:15]
    v_pk_fma_f32 v[28:29], v[14:15], v[24:25], v[28:29] op_sel:[0,0,0] op_sel_hi:[1,0,1]
    v_pk_add_f32 v[26:27], v[26:27], v[16:17]
    v_pk_fma_f32 v[28:29], v[24:25], v[16:17], v[28:29] op_sel:[1,0,0] op_sel_hi:[1,1,1]
    v_pk_add_f32 v[30:31], v[30:31], v[22:23]
    v_pk_add_f32 v[30:31], v[30:31], v[24:25]
    v_add_f32 v30, v30, v31
    v_add_f32_dpp v26, v26, v26 row_shr:1 row_mask:0xf bank_mask:0xf bound_ctrl:0
    v_add_f32_dpp v27, v27, v27 row_shr:1 row_mask:0xf bank_mask:0xf bound_ctrl:0
    v_add_f32_dpp v28, v28, v28 row_shr:1 row_mask:0xf bank_mask:0xf bound_ctrl:0
    v_add_f32_dpp v29, v29, v29 row_shr:1 row_mask:0xf bank_mask:0xf bound_ctrl:0
    v_add_f32_dpp v30, v30, v30 row_shr:1 row_mask:0xf bank_mask:0xf bound_ctrl:0
    v_add_f32_dpp v26, v26, v26 row_shr:2 row_mask:0xf bank_mask:0xf bound_ctrl:0
    v_add_f32_dpp v27, v27, v27 row_shr:2 row_mask:0xf bank_mask:0xf bound_ctrl:0
    v_add_f32_dpp v28, v28, v28 row_shr:2 row_mask:0xf bank_mask:0xf bound_ctrl:0
    v_add_f32_dpp v29, v29, v29 row_shr:2 row_mask:0xf bank_mask:0xf bound_ctrl:0
    v_add_f32_dpp v30, v30, v30 row_shr:2 row_mask:0xf bank_mask:0xf bound_ctrl:0
    v_add_f32_dpp v26, v26, v26 row_shr:4 row_mask:0xf bank_mask:0xf bound_ctrl:0
    v_add_f32_dpp v27, v27, v27 row_shr:4 row_mask:0xf bank_mask:0xf bound_ctrl:0
    v_add_f32_dpp v28, v28, v28 row_shr:4 row_mask:0xf bank_mask:0xf bound_ctrl:0
    v_add_f32_dpp v29, v29, v29 row_shr:4 row_mask:0xf bank_mask:0xf bound_ctrl:0
    v_add_f32_dpp v30, v30, v30 row_shr:4 row_mask:0xf bank_mask:0xf bound_ctrl:0
    v_add_f32_dpp v26, v26, v26 row_shr:8 row_mask:0xf bank_mask:0xf bound_ctrl:0
    v_add_f32_dpp v27, v27, v27 row_shr:8 row_mask:0xf bank_mask:0xf bound_ctrl:0
    v_add_f32_dpp v28, v28, v28 row_shr:8 row_mask:0xf bank_mask:0xf bound_ctrl:0
    v_add_f32_dpp v29, v29, v29 row_shr:8 row_mask:0xf bank_mask:0xf bound_ctrl:0
    v_add_f32_dpp v30, v30, v30 row_shr:8 row_mask:0xf bank_mask:0xf bound_ctrl:0
    v_add_f32_dpp v26, v26, v26 row_bcast:15 row_mask:0xa bank_mask:0xf
    v_add_f32_dpp v27, v27, v27 row_bcast:15 row_mask:0xa bank_mask:0xf
    v_add_f32_dpp v28, v28, v28 row_bcast:15 row_mask:0xa bank_mask:0xf
    v_add_f32_dpp v29, v29, v29 row_bcast:15 row_mask:0xa bank_mask:0xf
    v_add_f32_dpp v30, v30, v30 row_bcast:15 row_mask:0xa bank_mask:0xf
    v_add_f32_dpp v26, v26, v26 row_bcast:31 row_mask:0xc bank_mask:0xf
    v_add_f32_dpp v27, v27, v27 row_bcast:31 row_mask:0xc bank_mask:0xf
    v_add_f32_dpp v28, v28, v28 row_bcast:31 row_mask:0xc bank_mask:0xf
    v_add_f32_dpp v29, v29, v29 row_bcast:31 row_mask:0xc bank_mask:0xf
    v_add_f32_dpp v30, v30, v30 row_bcast:31 row_mask:0xc bank_mask:0xf
    v_readlane_b32 s52, v26, 63
    v_readlane_b32 s53, v27, 63
    s_nop 0
    v_mul_f32 v32, s52, v38
    v_mul_f32 v33, s53, v38
    v_pk_add_f32 v[2:3], v[2:3], v[32:33] neg_lo:[0,1] neg_hi:[0,1]
    v_pk_add_f32 v[4:5], v[4:5], v[32:33] neg_lo:[0,1] neg_hi:[0,1]
    v_pk_add_f32 v[6:7], v[6:7], v[32:33] neg_lo:[0,1] neg_hi:[0,1]
    v_pk_add_f32 v[8:9], v[8:9], v[32:33] neg_lo:[0,1] neg_hi:[0,1]
    v_pk_add_f32 v[10:11], v[10:11], v[32:33] neg_lo:[0,1] neg_hi:[0,1]
    v_pk_add_f32 v[12:13], v[12:13], v[32:33] neg_lo:[0,1] neg_hi:[0,1]
    v_pk_add_f32 v[14:15], v[14:15], v[32:33] neg_lo:[0,1] neg_hi:[0,1]
    v_pk_add_f32 v[16:17], v[16:17], v[32:33] neg_lo:[0,1] neg_hi:[0,1]
    v_pk_mul_f32 v[34:35], v[2:3], v[2:3]
    v_pk_fma_f32 v[34:35], v[4:5], v[4:5], v[34:35]
    v_pk_fma_f32 v[34:35], v[6:7], v[6:7], v[34:35]
    v_pk_fma_f32 v[34:35], v[8:9], v[8:9], v[34:35]
    v_pk_fma_f32 v[34:35], v[10:11], v[10:11], v[34:35]
    v_pk_fma_f32 v[34:35], v[12:13], v[12:13], v[34:35]
    v_pk_fma_f32 v[34:35], v[14:15], v[14:15], v[34:35]
    v_pk_fma_f32 v[34:35], v[16:17], v[16:17], v[34:35]
    v_pk_mul_f32 v[34:35], v[34:35], v[36:37]
    s_nop 1
    v_add_f32_dpp v34, v34, v34 row_shr:1 row_mask:0xf bank_mask:0xf bound_ctrl:0
    v_add_f32_dpp v35, v35, v35 row_shr:1 row_mask:0xf bank_mask:0xf bound_ctrl:0
    s_nop 0
    v_add_f32_dpp v34, v34, v34 row_shr:2 row_mask:0xf bank_mask:0xf bound_ctrl:0
    v_add_f32_dpp v35, v35, v35 row_shr:2 row_mask:0xf bank_mask:0xf bound_ctrl:0
    s_nop 0
    v_add_f32_dpp v34, v34, v34 row_shr:4 row_mask:0xf bank_mask:0xf bound_ctrl:0
    v_add_f32_dpp v35, v35, v35 row_shr:4 row_mask:0xf bank_mask:0xf bound_ctrl:0
    s_nop 0
    v_add_f32_dpp v34, v34, v34 row_shr:8 row_mask:0xf bank_mask:0xf bound_ctrl:0
    v_add_f32_dpp v35, v35, v35 row_shr:8 row_mask:0xf bank_mask:0xf bound_ctrl:0
    s_nop 0
    v_add_f32_dpp v34, v34, v34 row_bcast:15 row_mask:0xa bank_mask:0xf
    v_add_f32_dpp v35, v35, v35 row_bcast:15 row_mask:0xa bank_mask:0xf
    s_nop 0
    v_add_f32_dpp v34, v34, v34 row_bcast:31 row_mask:0xc bank_mask:0xf
    v_add_f32_dpp v35, v35, v35 row_bcast:31 row_mask:0xc bank_mask:0xf
    v_readlane_b32 s54, v34, 63
    v_readlane_b32 s55, v35, 63
    v_cvt_pk_bf16_f32 v46, v32, v33
    v_mul_f32 v44, s54, v38
    v_mul_f32 v45, s55, v38
    v_cvt_pk_bf16_f32 v47, v44, v45
    v_lshlrev_b32 v48, 16, v46
    v_and_b32 v49, 0xffff0000, v46
    v_lshlrev_b32 v44, 16, v47
    v_and_b32 v45, 0xffff0000, v47
    v_add_f32 v44, 0x3727c5ac, v44
    v_add_f32 v45, 0x3727c5ac, v45
    v_cvt_pk_bf16_f32 v47, v44, v45
    v_lshlrev_b32 v44, 16, v47
    v_and_b32 v45, 0xffff0000, v47
    v_sqrt_f32 v44, v44
    v_sqrt_f32 v45, v45
    v_fma_f32 v28, -v48, v30, v28
    v_fma_f32 v29, -v49, v30, v29
    v_cvt_pk_bf16_f32 v47, v44, v45
    s_mov_b32 s33, 0x05040100
    s_mov_b32 s34, 0x07060302
    v_lshlrev_b32 v44, 16, v47
    v_and_b32 v45, 0xffff0000, v47
    v_rcp_f32 v44, v44
    v_rcp_f32 v45, v45
    v_perm_b32 v41, v47, v46, s33
    v_perm_b32 v42, v47, v46, s34
    v_mov_b32 v40, s31
    v_mul_f32 v28, v28, v44
    v_mul_f32 v29, v29, v45
    v_cvt_pk_bf16_f32 v43, v28, v29
    s_mov_b32 exec_lo, 0
    s_mov_b32 exec_hi, 0x80000000
    global_store_dwordx4 v39, v[40:43], s[8:9] sc1
    s_mov_b64 exec, -1
    s_cmp_eq_u32 s32, 28
    s_cbranch_scc0 L_end
    v_lshlrev_b32 v18, 5, v0
    v_add_u32 v18, 4096, v18
    v_add_u32 v19, 8192, v18
    global_load_dwordx4 v[2:5], v18, s[8:9] offset:0 sc1
    global_load_dwordx4 v[6:9], v18, s[8:9] offset:16 sc1
    global_load_dwordx4 v[10:13], v19, s[8:9] offset:0 sc1
    global_load_dwordx4 v[14:17], v19, s[8:9] offset:16 sc1
    s_mov_b32 s50, 0
    s_waitcnt vmcnt(0)
L_irec_chk:
    v_cmp_ne_u32 vcc, s31, v2
    v_cmp_ne_u32 s[38:39], s31, v6
    s_nop 0
    s_or_b64 vcc, vcc, s[38:39]
    v_cmp_ne_u32 s[38:39], s31, v10
    s_nop 0
    s_or_b64 vcc, vcc, s[38:39]
    v_cmp_ne_u32 s[38:39], s31, v14
    s_nop 0
    s_or_b64 vcc, vcc, s[38:39]
    s_cbranch_vccz L_irec_ok
    s_add_u32 s50, s50, 1
    s_cmp_gt_u32 s50, 65536
    s_cbranch_scc1 L_irec_ok
    global_load_dwordx4 v[2:5], v18, s[8:9] offset:0 sc1
    global_load_dwordx4 v[6:9], v18, s[8:9] offset:16 sc1
    global_load_dwordx4 v[10:13], v19, s[8:9] offset:0 sc1
    global_load_dwordx4 v[14:17], v19, s[8:9] offset:16 sc1
    s_waitcnt vmcnt(0)
    s_branch L_irec_chk
L_irec_ok:
    v_lshlrev_b32 v28, 1, v0
    v_sub_u32 v28, 2047, v28
    s_mov_b32 s33, 0xffff0000
    s_lshl_b32 s34, s30, 3
    s_add_u32 s34, s34, 125952
    v_mov_b32 v29, s34
    v_pk_ashrrev_i16 v30, 15, v5 op_sel_hi:[0,1]
    v_subrev_u32 v31, 0, v28
    v_or_b32 v30, 0x80008000, v30
    v_subrev_u32 v34, 512, v28
    v_xor_b32 v30, v30, v5
    v_lshl_or_b32 v20, v30, 16, v31
    v_and_or_b32 v21, v30, s33, v34
    v_pk_ashrrev_i16 v30, 15, v9 op_sel_hi:[0,1]
    v_subrev_u32 v31, 1, v28
    v_or_b32 v30, 0x80008000, v30
    v_subrev_u32 v34, 513, v28
    v_xor_b32 v30, v30, v9
    v_lshl_or_b32 v22, v30, 16, v31
    v_and_or_b32 v23, v30, s33, v34
    v_pk_ashrrev_i16 v30, 15, v13 op_sel_hi:[0,1]
    v_subrev_u32 v31, 1024, v28
    v_or_b32 v30, 0x80008000, v30
    v_subrev_u32 v34, 1536, v28
    v_xor_b32 v30, v30, v13
    v_lshl_or_b32 v24, v30, 16, v31
    v_and_or_b32 v25, v30, s33, v34
    v_pk_ashrrev_i16 v30, 15, v17 op_sel_hi:[0,1]
    v_subrev_u32 v31, 1025, v28
    v_or_b32 v30, 0x80008000, v30
    v_subrev_u32 v34, 1537, v28
    v_xor_b32 v30, v30, v17
    v_lshl_or_b32 v26, v30, 16, v31
    v_and_or_b32 v27, v30, s33, v34
    v_max_u32 v32, v20, v21
    v_min_u32 v33, v20, v21
    v_med3_u32 v33, v32, v33, v22
    v_max_u32 v32, v32, v22
    v_med3_u32 v33, v32, v33, v23
    v_max_u32 v32, v32, v23
    v_med3_u32 v33, v32, v33, v24
    v_max_u32 v32, v32, v24
    v_med3_u32 v33, v32, v33, v25
    v_max_u32 v32, v32, v25
    v_med3_u32 v33, v32, v33, v26
    v_max_u32 v32, v32, v26
    v_med3_u32 v33, v32, v33, v27
    v_max_u32 v32, v32, v27
    s_nop 0
    v_max_u32_dpp v31, v33, v33 row_shr:1 row_mask:0xf bank_mask:0xf bound_ctrl:0
    v_min_u32_dpp v30, v32, v32 row_shr:1 row_mask:0xf bank_mask:0xf bound_ctrl:0
    v_max_u32_dpp v32, v32, v32 row_shr:1 row_mask:0xf bank_mask:0xf bound_ctrl:0
    v_max_u32 v33, v30, v31
    s_nop 1
    v_max_u32_dpp v31, v33, v33 row_shr:2 row_mask:0xf bank_mask:0xf bound_ctrl:0
    v_min_u32_dpp v30, v32, v32 row_shr:2 row_mask:0xf bank_mask:0xf bound_ctrl:0
    v_max_u32_dpp v32, v32, v32 row_shr:2 row_mask:0xf bank_mask:0xf bound_ctrl:0
    v_max_u32 v33, v30, v31
    s_nop 1
    v_max_u32_dpp v31, v33, v33 row_shr:4 row_mask:0xf bank_mask:0xf bound_ctrl:0
    v_min_u32_dpp v30, v32, v32 row_shr:4 row_mask:0xf bank_mask:0xf bound_ctrl:0
    v_max_u32_dpp v32, v32, v32 row_shr:4 row_mask:0xf bank_mask:0xf bound_ctrl:0
    v_max_u32 v33, v30, v31
    s_nop 1
    v_max_u32_dpp v31, v33, v33 row_shr:8 row_mask:0xf bank_mask:0xf bound_ctrl:0
    v_min_u32_dpp v30, v32, v32 row_shr:8 row_mask:0xf bank_mask:0xf bound_ctrl:0
    v_max_u32_dpp v32, v32, v32 row_shr:8 row_mask:0xf bank_mask:0xf bound_ctrl:0
    v_max_u32 v33, v30, v31
    s_nop 1
    v_max_u32_dpp v31, v33, v33 row_bcast:15 row_mask:0xa bank_mask:0xf
    v_min_u32_dpp v30, v32, v32 row_bcast:15 row_mask:0xa bank_mask:0xf
    v_max_u32_dpp v32, v32, v32 row_bcast:15 row_mask:0xa bank_mask:0xf
    v_max_u32 v33, v30, v31
    s_nop 1
    v_max_u32_dpp v31, v33, v33 row_bcast:31 row_mask:0xc bank_mask:0xf
    v_min_u32_dpp v30, v32, v32 row_bcast:31 row_mask:0xc bank_mask:0xf
    v_max_u32_dpp v32, v32, v32 row_bcast:31 row_mask:0xc bank_mask:0xf
    v_max_u32 v33, v30, v31
    s_mov_b32 exec_lo, 0
    s_mov_b32 exec_hi, 0x80000000
    ds_write_b64 v29, v[32:33]
    s_mov_b64 exec, -1
    s_waitcnt lgkmcnt(0)
    s_barrier
    v_and_b32 v24, 3, v1
    v_lshlrev_b32 v24, 3, v24
    v_add_u32 v24, 125952, v24
    ds_read_b64 v[22:23], v24
    s_waitcnt lgkmcnt(0)
    v_max_u32_dpp v21, v23, v23 row_shr:1 row_mask:0xf bank_mask:0xf bound_ctrl:0
    v_min_u32_dpp v20, v22, v22 row_shr:1 row_mask:0xf bank_mask:0xf bound_ctrl:0
    v_max_u32_dpp v22, v22, v22 row_shr:1 row_mask:0xf bank_mask:0xf bound_ctrl:0
    v_max_u32 v23, v20, v21
    s_nop 1
    v_max_u32_dpp v21, v23, v23 row_shr:2 row_mask:0xf bank_mask:0xf bound_ctrl:0
    v_min_u32_dpp v20, v22, v22 row_shr:2 row_mask:0xf bank_mask:0xf bound_ctrl:0
    v_max_u32_dpp v22, v22, v22 row_shr:2 row_mask:0xf bank_mask:0xf bound_ctrl:0
    v_max_u32 v23, v20, v21
    v_readlane_b32 s46, v22, 3
    v_readlane_b32 s47, v23, 3
    s_and_b32 s48, s46, 0x7ff
    s_and_b32 s49, s47, 0x7ff
    s_sub_u32 s48, 2047, s48
    s_sub_u32 s49, 2047, s49
    s_cmp_eq_u32 s30, 0
    s_cbranch_scc0 L_end
    v_mov_b32 v20, s31
    v_mov_b32 v21, s46
    v_mov_b32 v22, s47
    v_mov_b32 v23, s31
    v_mov_b32 v24, 256
    s_mov_b64 exec, 1
    global_store_dwordx4 v24, v[20:23], s[8:9] sc1
    s_mov_b64 exec, -1
L_end:
    s_endpgm
.section .rodata,"a"
.p2align 8
.type T1_table,@object
T1_table:
.long 116768,116768,116768,116768,116758,116758,116758,116758,116758,116758,116758,116756
.long 116758,116758,116758,116756,116756,116756,116756,116756,116756,116756,116756,116756
.long 116756,116756,116756,116756,116754,116754,116754,116754,116754,116754,116754,116752
.long 116754,116754,116754,116752,116752,116752,116752,116752,116752,116752,116752,116752
.long 116752,116752,116752,116752,116750,116750,116750,116750,116750,116750,116750,116748
.long 116750,116750,116750,116748,116748,116748,116748,116748,116748,116748,116748,116748
.long 116748,116748,116748,116748,116746,116746,116746,116746,116746,116746,116746,116744
.long 116746,116746,116746,116744,116744,116744,116744,116744,116744,116744,116744,116744
.long 116744,116744,116744,116744,116742,116742,116742,116742,116742,116742,116742,116740
.long 116742,116742,116742,116740,116740,116740,116740,116740,116740,116740,116740,116740
.long 116740,116740,116740,116740,116738,116738,116738,116738,116738,116738,116738,116736
.long 116738,116738,116738,116736,116736,116736,116736,116736,116736,116736,116736,116736
.long 116736,116736,116736,116736,116734,116734,116734,116734,116734,116734,116734,116732
.long 116734,116734,116734,116732,116732,116732,116732,116732,116732,116732,116732,116732
.long 116732,116732,116732,116732,116730,116730,116730,116730,116730,116730,116730,116728
.long 116730,116730,116730,116728,116728,116728,116728,116728,116728,116728,116728,116728
.long 116728,116728,116728,116728,116726,116726,116726,116726,116726,116726,116726,116724
.long 116726,116726,116726,116724,116724,116724,116724,116724,116724,116724,116724,116724
.long 116724,116724,116724,116724,116722,116722,116722,116722,116722,116722,116722,116720
.long 116722,116722,116722,116720,116720,116720,116720,116720,116720,116720,116720,116720
.long 116720,116720,116720,116720,116718,116718,116718,116718,116718,116718,116718,116716
.long 116718,116718,116718,116716,116716,116716,116716,116716,116716,116716,116716,116716
.long 116716,116716,116716,116716,116714,116714,116714,116714,116714,116714,116714,116712
.long 116714,116714,116714,116712,116712,116712,116712,116712,116712,116712,116712,116712
.long 116712,116712,116712,116712,116710,116710,116710,116710,116710,116710,116710,116708
.long 116710,116710,116710,116708,116708,116708,116708,116708,116708,116708,116708,116708
.long 116708,116708,116708,116708,116706,116706,116706,116706,116706,116706,116706,116704
.long 116706,116706,116706,116704,116704,116704,116704,116704,116704,116704,116704,116704
.long 116704,116704,116704,116704,116702,116702,116702,116702,116702,116702,116702,116700
.long 116702,116702,116702,116700,116700,116700,116700,116700,116700,116700,116700,116700
.long 116700,116700,116700,116700,116698,116698,116698,116698,116698,116698,116698,116696
.long 116698,116698,116698,116696,116696,116696,116696,116696,116696,116696,116696,116696
.long 116696,116696,116696,116696,116686,116686,116686,116686,116686,116686,116686,116684
.long 116686,116686,116686,116684,116684,116684,116684,116684,116684,116684,116684,116684
.long 116684,116684,116684,116684,116682,116682,116682,116682,116682,116682,116682,116680
.long 116682,116682,116682,116680,116680,116680,116680,116680,116680,116680,116680,116680
.long 116680,116680,116680,116680,116678,116678,116678,116678,116678,116678,116678,116676
.long 116678,116678,116678,116676,116676,116676,116676,116676,116676,116676,116676,116676
.long 116676,116676,116676,116676,116674,116674,116674,116674,116674,116674,116674,116672
.long 116674,116674,116674,116672,116672,116672,116672,116672,116672,116672,116672,116672
.long 116672,116672,116672,116672,116670,116670,116670,116670,116670,116670,116670,116668
.long 116670,116670,116670,116668,116668,116668,116668,116668,116668,116668,116668,116668
.long 116668,116668,116668,116668,116666,116666,116666,116666,116666,116666,116666,116664
.long 116666,116666,116666,116664,116664,116664,116664,116664,116664,116664,116664,116664
.long 116664,116664,116664,116664,116662,116662,116662,116662,116662,116662,116662,116660
.long 116662,116662,116662,116660,116660,116660,116660,116660,116660,116660,116660,116660
.long 116660,116660,116660,116660,116658,116658,116658,116658,116658,116658,116658,116656
.long 116658,116658,116658,116656,116656,116656,116656,116656,116656,116656,116656,116656
.long 116656,116656,116656,116656,116654,116654,116654,116654,116654,116654,116654,116652
.long 116654,116654,116654,116652,116652,116652,116652,116652,116652,116652,116652,116652
.long 116652,116652,116652,116652,116650,116650,116650,116650,116650,116650,116650,116648
.long 116650,116650,116650,116648,116648,116648,116648,116648,116648,116648,116648,116648
.long 116648,116648,116648,116648,116646,116646,116646,116646,116646,116646,116646,116644
.long 116646,116646,116646,116644,116644,116644,116644,116644,116644,116644,116644,116644
.long 116644,116644,116644,116644,116642,116642,116642,116642,116642,116642,116642,116640
.long 116642,116642,116642,116640,116640,116640,116640,116640,116640,116640,116640,116640
.long 116640,116640,116640,116640,116638,116638,116638,116638,116638,116638,116638,116636
.long 116638,116638,116638,116636,116636,116636,116636,116636,116636,116636,116636,116636
.long 116636,116636,116636,116636,116634,116634,116634,116634,116634,116634,116634,116632
.long 116634,116634,116634,116632,116632,116632,116632,116632,116632,116632,116632,116632
.long 116632,116632,116632,116632,116630,116630,116630,116630,116630,116630,116630,116628
.long 116630,116630,116630,116628,116628,116628,116628,116628,116628,116628,116628,116628
.long 116628,116628,116628,116628,116626,116626,116626,116626,116626,116626,116626,116624
.long 116626,116626,116626,116624,116624,116624,116624,116624,116624,116624,116624,116624
.long 116624,116624,116624,116624,116614,116614,116614,116614,116614,116614,116614,116612
.long 116614,116614,116614,116612,116612,116612,116612,116612,116612,116612,116612,116612
.long 116612,116612,116612,116612,116610,116610,116610,116610,116610,116610,116610,116608
.long 116610,116610,116610,116608,116608,116608,116608,116608,116608,116608,116608,116608
.long 116608,116608,116608,116608,116606,116606,116606,116606,116606,116606,116606,116604
.long 116606,116606,116606,116604,116604,116604,116604,116604,116604,116604,116604,116604
.long 116604,116604,116604,116604,116602,116602,116602,116602,116602,116602,116602,116600
.long 116602,116602,116602,116600,116600,116600,116600,116600,116600,116600,116600,116600
.long 116600,116600,116600,116600,116598,116598,116598,116598,116598,116598,116598,116596
.long 116598,116598,116598,116596,116596,116596,116596,116596,116596,116596,116596,116596
.long 116596,116596,116596,116596,116594,116594,116594,116594,116594,116594,116594,116592
.long 116594,116594,116594,116592,116592,116592,116592,116592,116592,116592,116592,116592
.long 116592,116592,116592,116592,116590,116590,116590,116590,116590,116590,116590,116588
.long 116590,116590,116590,116588,116588,116588,116588,116588,116588,116588,116588,116588
.long 116588,116588,116588,116588,116586,116586,116586,116586,116586,116586,116586,116584
.long 116586,116586,116586,116584,116584,116584,116584,116584,116584,116584,116584,116584
.long 116584,116584,116584,116584,116582,116582,116582,116582,116582,116582,116582,116580
.long 116582,116582,116582,116580,116580,116580,116580,116580,116580,116580,116580,116580
.long 116580,116580,116580,116580,116578,116578,116578,116578,116578,116578,116578,116576
.long 116578,116578,116578,116576,116576,116576,116576,116576,116576,116576,116576,116576
.long 116576,116576,116576,116576,116574,116574,116574,116574,116574,116574,116574,116572
.long 116574,116574,116574,116572,116572,116572,116572,116572,116572,116572,116572,116572
.long 116572,116572,116572,116572,116570,116570,116570,116570,116570,116570,116570,116568
.long 116570,116570,116570,116568,116568,116568,116568,116568,116568,116568,116568,116568
.long 116568,116568,116568,116568,116566,116566,116566,116566,116566,116566,116566,116564
.long 116566,116566,116566,116564,116564,116564,116564,116564,116564,116564,116564,116564
.long 116564,116564,116564,116564,116562,116562,116562,116562,116562,116562,116562,116560
.long 116562,116562,116562,116560,116560,116560,116560,116560,116560,116560,116560,116560
.long 116560,116560,116560,116560,116558,116558,116558,116558,116558,116558,116558,116556
.long 116558,116558,116558,116556,116556,116556,116556,116556,116556,116556,116556,116556
.long 116556,116556,116556,116556,116554,116554,116554,116554,116554,116554,116554,116552
.long 116554,116554,116554,116552,116552,116552,116552,116552,116552,116552,116552,116552
.long 116552,116552,116552,116552,116542,116542,116542,116542,116542,116542,116542,116540
.long 116542,116542,116542,116540,116540,116540,116540,116540,116540,116540,116540,116540
.long 116540,116540,116540,116540,116538,116538,116538,116538,116538,116538,116538,116536
.long 116538,116538,116538,116536,116536,116536,116536,116536,116536,116536,116536,116536
.long 116536,116536,116536,116536,116534,116534,116534,116534,116534,116534,116534,116532
.long 116534,116534,116534,116532,116532,116532,116532,116532,116532,116532,116532,116532
.long 116532,116532,116532,116532,116530,116530,116530,116530,116530,116530,116530,116528
.long 116530,116530,116530,116528,116528,116528,116528,116528,116528,116528,116528,116528
.long 116528,116528,116528,116528,116526,116526,116526,116526,116526,116526,116526,116524
.long 116526,116526,116526,116524,116524,116524,116524,116524,116524,116524,116524,116524
.long 116524,116524,116524,116524,116522,116522,116522,116522,116522,116522,116522,116520
.long 116522,116522,116522,116520,116520,116520,116520,116520,116520,116520,116520,116520
.long 116520,116520,116520,116520,116518,116518,116518,116518,116518,116518,116518,116516
.long 116518,116518,116518,116516,116516,116516,116516,116516,116516,116516,116516,116516
.long 116516,116516,116516,116516,116514,116514,116514,116514,116514,116514,116514,116512
.long 116514,116514,116514,116512,116512,116512,116512,116512,116512,116512,116512,116512
.long 116512,116512,116512,116512,116510,116510,116510,116510,116510,116510,116510,116508
.long 116510,116510,116510,116508,116508,116508,116508,116508,116508,116508,116508,116508
.long 116508,116508,116508,116508,116506,116506,116506,116506,116506,116506,116506,116504
.long 116506,116506,116506,116504,116504,116504,116504,116504,116504,116504,116504,116504
.long 116504,116504,116504,116504,116502,116502,116502,116502,116502,116502,116502,116500
.long 116502,116502,116502,116500,116500,116500,116500,116500,116500,116500,116500,116500
.long 116500,116500,116500,116500,116498,116498,116498,116498,116498,116498,116498,116496
.long 116498,116498,116498,116496,116496,116496,116496,116496,116496,116496,116496,116496
.long 116496,116496,116496,116496,116494,116494,116494,116494,116494,116494,116494,116492
.long 116494,116494,116494,116492,116492,116492,116492,116492,116492,116492,116492,116492
.long 116492,116492,116492,116492,116490,116490,116490,116490,116490,116490,116490,116488
.long 116490,116490,116490,116488,116488,116488,116488,116488,116488,116488,116488,116488
.long 116488,116488,116488,116488,116486,116486,116486,116486,116486,116486,116486,116484
.long 116486,116486,116486,116484,116484,116484,116484,116484,116484,116484,116484,116484
.long 116484,116484,116484,116484,116482,116482,116482,116482,116482,116482,116482,116480
.long 116482,116482,116482,116480,116480,116480,116480,116480,116480,116480,116470,116470
.long 116480,116480,116470,116470,116470,116398,116398,116398,116398,116398,116468,116468
.long 116398,116398,116468,116468,116468,116396,116396,116396,116396,116396,116466,116466
.long 116396,116396,116466,116466,116466,116394,116394,116394,116394,116394,116464,116464
.long 116394,116394,116464,116464,116464,116392,116392,116392,116392,116392,116462,116462
.long 116392,116392,116462,116462,116462,116390,116390,116390,116390,116390,116460,116460
.long 116390,116390,116460,116460,116460,116388,116388,116388,116388,116388,116458,116458
.long 116388,116388,116458,116458,116458,116386,116386,116386,116386,116386,116456,116456
.long 116386,116386,116456,116456,116456,116384,116384,116384,116384,116384,116454,116454
.long 116384,116384,116454,116454,116454,116382,116382,116382,116382,116382,116452,116452
.long 116382,116382,116452,116452,116452,116380,116380,116380,116380,116380,116450,116450
.long 116380,116380,116450,116450,116450,116378,116378,116378,116378,116378,116448,116448
.long 116378,116378,116448,116448,116448,116376,116376,116376,116376,116376,116446,116446
.long 116376,116376,116446,116446,116446,116374,116374,116374,116374,116374,116444,116444
.long 116374,116374,116444,116444,116444,116372,116372,116372,116372,116372,116442,116442
.long 116372,116372,116442,116442,116442,116370,116370,116370,116370,116370,116440,116440
.long 116370,116370,116440,116440,116440,116368,116368,116368,116368,116368,116438,116438
.long 116368,116368,116438,116438,116438,116366,116366,116366,116366,116366,116436,116436
.long 116366,116366,116436,116436,116436,116364,116364,116364,116364,116364,116434,116434
.long 116364,116364,116434,116434,116434,116362,116362,116362,116362,116362,116432,116432
.long 116362,116362,116432,116432,116432,116360,116360,116360,116360,116360,116430,116430
.long 116360,116360,116430,116430,116430,116358,116358,116358,116358,116358,116428,116428
.long 116358,116358,116428,116428,116428,116356,116356,116356,116356,116356,116426,116426
.long 116356,116356,116426,116426,116426,116354,116354,116354,116354,116354,116424,116424
.long 116354,116354,116424,116424,116424,116352,116352,116352,116352,116352,116422,116422
.long 116352,116352,116422,116422,116422,116350,116350,116350,116350,116350,116420,116420
.long 116350,116350,116420,116420,116420,116348,116348,116348,116348,116348,116418,116418
.long 116348,116348,116418,116418,116418,116346,116346,116346,116346,116346,116416,116416
.long 116346,116346,116416,116416,116416,116344,116344,116344,116344,116344,116414,116414
.long 116344,116344,116414,116414,116414,116342,116342,116342,116342,116342,116412,116412
.long 116342,116342,116412,116412,116412,116340,116340,116340,116340,116340,116410,116410
.long 116340,116340,116410,116410,116410,116338,116338,116338,116338,116338,116408,116408
.long 116338,116338,116408,116408,116408,116336,116336,116336,116336,116336,116326,116326
.long 116336,116336,116326,116326,116326,116254,116254,116254,116254,116254,116324,116324
.long 116254,116254,116324,116324,116324,116252,116252,116252,116252,116252,116322,116322
.long 116252,116252,116322,116322,116322,116250,116250,116250,116250,116250,116320,116320
.long 116250,116250,116320,116320,116320,116248,116248,116248,116248,116248,116318,116318
.long 116248,116248,116318,116318,116318,116246,116246,116246,116246,116246,116316,116316
.long 116246,116246,116316,116316,116316,116244,116244,116244,116244,116244,116314,116314
.long 116244,116244,116314,116314,116314,116242,116242,116242,116242,116242,116312,116312
.long 116242,116242,116312,116312,116312,116240,116240,116240,116240,116240,116310,116310
.long 116240,116240,116310,116310,116310,116238,116238,116238,116238,116238,116308,116308
.long 116238,116238,116308,116308,116308,116236,116236,116236,116236,116236,116306,116306
.long 116236,116236,116306,116306,116306,116234,116234,116234,116234,116234,116304,116304
.long 116234,116234,116304,116304,116304,116232,116232,116232,116232,116232,116302,116302
.long 116232,116232,116302,116302,116302,116230,116230,116230,116230,116230,116300,116300
.long 116230,116230,116300,116300,116300,116228,116228,116228,116228,116228,116298,116298
.long 116228,116228,116298,116298,116298,116226,116226,116226,116226,116226,116296,116296
.long 116226,116226,116296,116296,116296,116224,116224,116224,116224,116224,116294,116294
.long 116224,116224,116294,116294,116294,116222,116222,116222,116222,116222,116292,116292
.long 116222,116222,116292,116292,116292,116220,116220,116220,116220,116220,116290,116290
.long 116220,116220,116290,116290,116290,116218,116218,116218,116218,116218,116288,116288
.long 116218,116218,116288,116288,116288,116216,116216,116216,116216,116216,116286,116286
.long 116216,116216,116286,116286,116286,116214,116214,116214,116214,116214,116284,116284
.long 116214,116214,116284,116284,116284,116212,116212,116212,116212,116212,116282,116282
.long 116212,116212,116282,116282,116282,116210,116210,116210,116210,116210,116280,116280
.long 116210,116210,116280,116280,116280,116208,116208,116208,116208,116208,116278,116278
.long 116208,116208,116278,116278,116278,116206,116206,116206,116206,116206,116276,116276
.long 116206,116206,116276,116276,116276,116204,116204,116204,116204,116204,116274,116274
.long 116204,116204,116274,116274,116274,116202,116202,116202,116202,116202,116272,116272
.long 116202,116202,116272,116272,116272,116200,116200,116200,116200,116200,116270,116270
.long 116200,116200,116270,116270,116270,116198,116198,116198,116198,116198,116268,116268
.long 116198,116198,116268,116268,116268,116196,116196,116196,116196,116196,116266,116266
.long 116196,116196,116266,116266,116266,116194,116194,116194,116194,116194,116264,116264
.long 116194,116194,116264,116264,116264,116192,116192,116192,116192,116182,116110,116110
.long 116192,116182,116110,116110,116110,116038,115966,115966,115966,116180,116108,116108
.long 115966,116180,116108,116108,116108,116036,115964,115964,115964,116178,116106,116106
.long 115964,116178,116106,116106,116106,116034,115962,115962,115962,116176,116104,116104
.long 115962,116176,116104,116104,116104,116032,115960,115960,115960,116174,116102,116102
.long 115960,116174,116102,116102,116102,116030,115958,115958,115958,116172,116100,116100
.long 115958,116172,116100,116100,116100,116028,115956,115956,115956,116170,116098,116098
.long 115956,116170,116098,116098,116098,116026,115954,115954,115954,116168,116096,116096
.long 115954,116168,116096,116096,116096,116024,115952,115952,115952,116166,116094,116094
.long 115952,116166,116094,116094,116094,116022,115950,115950,115950,116164,116092,116092
.long 115950,116164,116092,116092,116092,116020,115948,115948,115948,116162,116090,116090
.long 115948,116162,116090,116090,116090,116018,115946,115946,115946,116160,116088,116088
.long 115946,116160,116088,116088,116088,116016,115944,115944,115944,116158,116086,116086
.long 115944,116158,116086,116086,116086,116014,115942,115942,115942,116156,116084,116084
.long 115942,116156,116084,116084,116084,116012,115940,115940,115940,116154,116082,116082
.long 115940,116154,116082,116082,116082,116010,115938,115938,115938,116152,116080,116080
.long 115938,116152,116080,116080,116080,116008,115936,115936,115936,116150,116078,116078
.long 115936,116150,116078,116078,116078,116006,115934,115934,115934,116148,116076,116076
.long 115934,116148,116076,116076,116076,116004,115932,115932,115932,116146,116074,116074
.long 115932,116146,116074,116074,116074,116002,115930,115930,115930,116144,116072,116072
.long 115930,116144,116072,116072,116072,116000,115928,115928,115928,116142,116070,116070
.long 115928,116142,116070,116070,116070,115998,115926,115926,115926,116140,116068,116068
.long 115926,116140,116068,116068,116068,115996,115924,115924,115924,116138,116066,116066
.long 115924,116138,116066,116066,116066,115994,115922,115922,115922,116136,116064,116064
.long 115922,116136,116064,116064,116064,115992,115920,115920,115920,116134,116062,116062
.long 115920,116134,116062,116062,116062,115990,115918,115918,115918,116132,116060,116060
.long 115918,116132,116060,116060,116060,115988,115916,115916,115916,116130,116058,116058
.long 115916,116130,116058,116058,116058,115986,115914,115914,115914,116128,116056,116056
.long 115914,116128,116056,116056,116056,115984,115912,115912,115912,116126,116054,116054
.long 115912,116126,116054,116054,116054,115982,115910,115910,115910,116124,116052,116052
.long 115910,116124,116052,116052,116052,115980,115908,115908,115908,116122,116050,116050
.long 115908,116122,116050,116050,116050,115978,115906,115906,115906,116120,116048,116048
.long 115906,116120,116048,116048,116048,115976,115904,115904,115894,115822,115750,115678
.long 115894,115822,115750,115678,115606,115534,115462,115390,115892,115820,115748,115676
.long 115892,115820,115748,115676,115604,115532,115460,115388,115890,115818,115746,115674
.long 115890,115818,115746,115674,115602,115530,115458,115386,115888,115816,115744,115672
.long 115888,115816,115744,115672,115600,115528,115456,115384,115886,115814,115742,115670
.long 115886,115814,115742,115670,115598,115526,115454,115382,115884,115812,115740,115668
.long 115884,115812,115740,115668,115596,115524,115452,115380,115882,115810,115738,115666
.long 115882,115810,115738,115666,115594,115522,115450,115378,115880,115808,115736,115664
.long 115880,115808,115736,115664,115592,115520,115448,115376,115878,115806,115734,115662
.long 115878,115806,115734,115662,115590,115518,115446,115374,115876,115804,115732,115660
.long 115876,115804,115732,115660,115588,115516,115444,115372,115874,115802,115730,115658
.long 115874,115802,115730,115658,115586,115514,115442,115370,115872,115800,115728,115656
.long 115872,115800,115728,115656,115584,115512,115440,115368,115870,115798,115726,115654
.long 115870,115798,115726,115654,115582,115510,115438,115366,115868,115796,115724,115652
.long 115868,115796,115724,115652,115580,115508,115436,115364,115866,115794,115722,115650
.long 115866,115794,115722,115650,115578,115506,115434,115362,115864,115792,115720,115648
.long 115864,115792,115720,115648,115576,115504,115432,115360,115862,115790,115718,115646
.long 115862,115790,115718,115646,115574,115502,115430,115358,115860,115788,115716,115644
.long 115860,115788,115716,115644,115572,115500,115428,115356,115858,115786,115714,115642
.long 115858,115786,115714,115642,115570,115498,115426,115354,115856,115784,115712,115640
.long 115856,115784,115712,115640,115568,115496,115424,115352,115854,115782,115710,115638
.long 115854,115782,115710,115638,115566,115494,115422,115350,115852,115780,115708,115636
.long 115852,115780,115708,115636,115564,115492,115420,115348,115850,115778,115706,115634
.long 115850,115778,115706,115634,115562,115490,115418,115346,115848,115776,115704,115632
.long 115848,115776,115704,115632,115560,115488,115416,115344,115846,115774,115702,115630
.long 115846,115774,115702,115630,115558,115486,115414,115342,115844,115772,115700,115628
.long 115844,115772,115700,115628,115556,115484,115412,115340,115842,115770,115698,115626
.long 115842,115770,115698,115626,115554,115482,115410,115338,115840,115768,115696,115624
.long 115840,115768,115696,115624,115552,115480,115408,115336,115838,115766,115694,115622
.long 115838,115766,115694,115622,115550,115478,115406,115334,115836,115764,115692,115620
.long 115836,115764,115692,115620,115548,115476,115404,115332,115834,115762,115690,115618
.long 115834,115762,115690,115618,115546,115474,115402,115330,115832,115760,115688,115616
.long 115832,115760,115688,115616,115544,115472,115400,115328,116840,116840,116840,116840
.long 118304,118304,118304,118304,118294,118294,118294,118294,118294,118294,118294,118292
.long 118294,118294,118294,118292,118292,118292,118292,118292,118292,118292,118292,118292
.long 118292,118292,118292,118292,118290,118290,118290,118290,118290,118290,118290,118288
.long 118290,118290,118290,118288,118288,118288,118288,118288,118288,118288,118288,118288
.long 118288,118288,118288,118288,118286,118286,118286,118286,118286,118286,118286,118284
.long 118286,118286,118286,118284,118284,118284,118284,118284,118284,118284,118284,118284
.long 118284,118284,118284,118284,118282,118282,118282,118282,118282,118282,118282,118280
.long 118282,118282,118282,118280,118280,118280,118280,118280,118280,118280,118280,118280
.long 118280,118280,118280,118280,118278,118278,118278,118278,118278,118278,118278,118276
.long 118278,118278,118278,118276,118276,118276,118276,118276,118276,118276,118276,118276
.long 118276,118276,118276,118276,118274,118274,118274,118274,118274,118274,118274,118272
.long 118274,118274,118274,118272,118272,118272,118272,118272,118272,118272,118272,118272
.long 118272,118272,118272,118272,118270,118270,118270,118270,118270,118270,118270,118268
.long 118270,118270,118270,118268,118268,118268,118268,118268,118268,118268,118268,118268
.long 118268,118268,118268,118268,118266,118266,118266,118266,118266,118266,118266,118264
.long 118266,118266,118266,118264,118264,118264,118264,118264,118264,118264,118264,118264
.long 118264,118264,118264,118264,118262,118262,118262,118262,118262,118262,118262,118260
.long 118262,118262,118262,118260,118260,118260,118260,118260,118260,118260,118260,118260
.long 118260,118260,118260,118260,118258,118258,118258,118258,118258,118258,118258,118256
.long 118258,118258,118258,118256,118256,118256,118256,118256,118256,118256,118256,118256
.long 118256,118256,118256,118256,118254,118254,118254,118254,118254,118254,118254,118252
.long 118254,118254,118254,118252,118252,118252,118252,118252,118252,118252,118252,118252
.long 118252,118252,118252,118252,118250,118250,118250,118250,118250,118250,118250,118248
.long 118250,118250,118250,118248,118248,118248,118248,118248,118248,118248,118248,118248
.long 118248,118248,118248,118248,118246,118246,118246,118246,118246,118246,118246,118244
.long 118246,118246,118246,118244,118244,118244,118244,118244,118244,118244,118244,118244
.long 118244,118244,118244,118244,118242,118242,118242,118242,118242,118242,118242,118240
.long 118242,118242,118242,118240,118240,118240,118240,118240,118240,118240,118240,118240
.long 118240,118240,118240,118240,118238,118238,118238,118238,118238,118238,118238,118236
.long 118238,118238,118238,118236,118236,118236,118236,118236,118236,118236,118236,118236
.long 118236,118236,118236,118236,118234,118234,118234,118234,118234,118234,118234,118232
.long 118234,118234,118234,118232,118232,118232,118232,118232,118232,118232,118232,118232
.long 118232,118232,118232,118232,118222,118222,118222,118222,118222,118222,118222,118220
.long 118222,118222,118222,118220,118220,118220,118220,118220,118220,118220,118220,118220
.long 118220,118220,118220,118220,118218,118218,118218,118218,118218,118218,118218,118216
.long 118218,118218,118218,118216,118216,118216,118216,118216,118216,118216,118216,118216
.long 118216,118216,118216,118216,118214,118214,118214,118214,118214,118214,118214,118212
.long 118214,118214,118214,118212,118212,118212,118212,118212,118212,118212,118212,118212
.long 118212,118212,118212,118212,118210,118210,118210,118210,118210,118210,118210,118208
.long 118210,118210,118210,118208,118208,118208,118208,118208,118208,118208,118208,118208
.long 118208,118208,118208,118208,118206,118206,118206,118206,118206,118206,118206,118204
.long 118206,118206,118206,118204,118204,118204,118204,118204,118204,118204,118204,118204
.long 118204,118204,118204,118204,118202,118202,118202,118202,118202,118202,118202,118200
.long 118202,118202,118202,118200,118200,118200,118200,118200,118200,118200,118200,118200
.long 118200,118200,118200,118200,118198,118198,118198,118198,118198,118198,118198,118196
.long 118198,118198,118198,118196,118196,118196,118196,118196,118196,118196,118196,118196
.long 118196,118196,118196,118196,118194,118194,118194,118194,118194,118194,118194,118192
.long 118194,118194,118194,118192,118192,118192,118192,118192,118192,118192,118192,118192
.long 118192,118192,118192,118192,118190,118190,118190,118190,118190,118190,118190,118188
.long 118190,118190,118190,118188,118188,118188,118188,118188,118188,118188,118188,118188
.long 118188,118188,118188,118188,118186,118186,118186,118186,118186,118186,118186,118184
.long 118186,118186,118186,118184,118184,118184,118184,118184,118184,118184,118184,118184
.long 118184,118184,118184,118184,118182,118182,118182,118182,118182,118182,118182,118180
.long 118182,118182,118182,118180,118180,118180,118180,118180,118180,118180,118180,118180
.long 118180,118180,118180,118180,118178,118178,118178,118178,118178,118178,118178,118176
.long 118178,118178,118178,118176,118176,118176,118176,118176,118176,118176,118176,118176
.long 118176,118176,118176,118176,118174,118174,118174,118174,118174,118174,118174,118172
.long 118174,118174,118174,118172,118172,118172,118172,118172,118172,118172,118172,118172
.long 118172,118172,118172,118172,118170,118170,118170,118170,118170,118170,118170,118168
.long 118170,118170,118170,118168,118168,118168,118168,118168,118168,118168,118168,118168
.long 118168,118168,118168,118168,118166,118166,118166,118166,118166,118166,118166,118164
.long 118166,118166,118166,118164,118164,118164,118164,118164,118164,118164,118164,118164
.long 118164,118164,118164,118164,118162,118162,118162,118162,118162,118162,118162,118160
.long 118162,118162,118162,118160,118160,118160,118160,118160,118160,118160,118160,118160
.long 118160,118160,118160,118160,118150,118150,118150,118150,118150,118150,118150,118148
.long 118150,118150,118150,118148,118148,118148,118148,118148,118148,118148,118148,118148
.long 118148,118148,118148,118148,118146,118146,118146,118146,118146,118146,118146,118144
.long 118146,118146,118146,118144,118144,118144,118144,118144,118144,118144,118144,118144
.long 118144,118144,118144,118144,118142,118142,118142,118142,118142,118142,118142,118140
.long 118142,118142,118142,118140,118140,118140,118140,118140,118140,118140,118140,118140
.long 118140,118140,118140,118140,118138,118138,118138,118138,118138,118138,118138,118136
.long 118138,118138,118138,118136,118136,118136,118136,118136,118136,118136,118136,118136
.long 118136,118136,118136,118136,118134,118134,118134,118134,118134,118134,118134,118132
.long 118134,118134,118134,118132,118132,118132,118132,118132,118132,118132,118132,118132
.long 118132,118132,118132,118132,118130,118130,118130,118130,118130,118130,118130,118128
.long 118130,118130,118130,118128,118128,118128,118128,118128,118128,118128,118128,118128
.long 118128,118128,118128,118128,118126,118126,118126,118126,118126,118126,118126,118124
.long 118126,118126,118126,118124,118124,118124,118124,118124,118124,118124,118124,118124
.long 118124,118124,118124,118124,118122,118122,118122,118122,118122,118122,118122,118120
.long 118122,118122,118122,118120,118120,118120,118120,118120,118120,118120,118120,118120
.long 118120,118120,118120,118120,118118,118118,118118,118118,118118,118118,118118,118116
.long 118118,118118,118118,118116,118116,118116,118116,118116,118116,118116,118116,118116
.long 118116,118116,118116,118116,118114,118114,118114,118114,118114,118114,118114,118112
.long 118114,118114,118114,118112,118112,118112,118112,118112,118112,118112,118112,118112
.long 118112,118112,118112,118112,118110,118110,118110,118110,118110,118110,118110,118108
.long 118110,118110,118110,118108,118108,118108,118108,118108,118108,118108,118108,118108
.long 118108,118108,118108,118108,118106,118106,118106,118106,118106,118106,118106,118104
.long 118106,118106,118106,118104,118104,118104,118104,118104,118104,118104,118104,118104
.long 118104,118104,118104,118104,118102,118102,118102,118102,118102,118102,118102,118100
.long 118102,118102,118102,118100,118100,118100,118100,118100,118100,118100,118100,118100
.long 118100,118100,118100,118100,118098,118098,118098,118098,118098,118098,118098,118096
.long 118098,118098,118098,118096,118096,118096,118096,118096,118096,118096,118096,118096
.long 118096,118096,118096,118096,118094,118094,118094,118094,118094,118094,118094,118092
.long 118094,118094,118094,118092,118092,118092,118092,118092,118092,118092,118092,118092
.long 118092,118092,118092,118092,118090,118090,118090,118090,118090,118090,118090,118088
.long 118090,118090,118090,118088,118088,118088,118088,118088,118088,118088,118088,118088
.long 118088,118088,118088,118088,118078,118078,118078,118078,118078,118078,118078,118076
.long 118078,118078,118078,118076,118076,118076,118076,118076,118076,118076,118076,118076
.long 118076,118076,118076,118076,118074,118074,118074,118074,118074,118074,118074,118072
.long 118074,118074,118074,118072,118072,118072,118072,118072,118072,118072,118072,118072
.long 118072,118072,118072,118072,118070,118070,118070,118070,118070,118070,118070,118068
.long 118070,118070,118070,118068,118068,118068,118068,118068,118068,118068,118068,118068
.long 118068,118068,118068,118068,118066,118066,118066,118066,118066,118066,118066,118064
.long 118066,118066,118066,118064,118064,118064,118064,118064,118064,118064,118064,118064
.long 118064,118064,118064,118064,118062,118062,118062,118062,118062,118062,118062,118060
.long 118062,118062,118062,118060,118060,118060,118060,118060,118060,118060,118060,118060
.long 118060,118060,118060,118060,118058,118058,118058,118058,118058,118058,118058,118056
.long 118058,118058,118058,118056,118056,118056,118056,118056,118056,118056,118056,118056
.long 118056,118056,118056,118056,118054,118054,118054,118054,118054,118054,118054,118052
.long 118054,118054,118054,118052,118052,118052,118052,118052,118052,118052,118052,118052
.long 118052,118052,118052,118052,118050,118050,118050,118050,118050,118050,118050,118048
.long 118050,118050,118050,118048,118048,118048,118048,118048,118048,118048,118048,118048
.long 118048,118048,118048,118048,118046,118046,118046,118046,118046,118046,118046,118044
.long 118046,118046,118046,118044,118044,118044,118044,118044,118044,118044,118044,118044
.long 118044,118044,118044,118044,118042,118042,118042,118042,118042,118042,118042,118040
.long 118042,118042,118042,118040,118040,118040,118040,118040,118040,118040,118040,118040
.long 118040,118040,118040,118040,118038,118038,118038,118038,118038,118038,118038,118036
.long 118038,118038,118038,118036,118036,118036,118036,118036,118036,118036,118036,118036
.long 118036,118036,118036,118036,118034,118034,118034,118034,118034,118034,118034,118032
.long 118034,118034,118034,118032,118032,118032,118032,118032,118032,118032,118032,118032
.long 118032,118032,118032,118032,118030,118030,118030,118030,118030,118030,118030,118028
.long 118030,118030,118030,118028,118028,118028,118028,118028,118028,118028,118028,118028
.long 118028,118028,118028,118028,118026,118026,118026,118026,118026,118026,118026,118024
.long 118026,118026,118026,118024,118024,118024,118024,118024,118024,118024,118024,118024
.long 118024,118024,118024,118024,118022,118022,118022,118022,118022,118022,118022,118020
.long 118022,118022,118022,118020,118020,118020,118020,118020,118020,118020,118020,118020
.long 118020,118020,118020,118020,118018,118018,118018,118018,118018,118018,118018,118016
.long 118018,118018,118018,118016,118016,118016,118016,118016,118016,118016,118006,118006
.long 118016,118016,118006,118006,118006,117934,117934,117934,117934,117934,118004,118004
.long 117934,117934,118004,118004,118004,117932,117932,117932,117932,117932,118002,118002
.long 117932,117932,118002,118002,118002,117930,117930,117930,117930,117930,118000,118000
.long 117930,117930,118000,118000,118000,117928,117928,117928,117928,117928,117998,117998
.long 117928,117928,117998,117998,117998,117926,117926,117926,117926,117926,117996,117996
.long 117926,117926,117996,117996,117996,117924,117924,117924,117924,117924,117994,117994
.long 117924,117924,117994,117994,117994,117922,117922,117922,117922,117922,117992,117992
.long 117922,117922,117992,117992,117992,117920,117920,117920,117920,117920,117990,117990
.long 117920,117920,117990,117990,117990,117918,117918,117918,117918,117918,117988,117988
.long 117918,117918,117988,117988,117988,117916,117916,117916,117916,117916,117986,117986
.long 117916,117916,117986,117986,117986,117914,117914,117914,117914,117914,117984,117984
.long 117914,117914,117984,117984,117984,117912,117912,117912,117912,117912,117982,117982
.long 117912,117912,117982,117982,117982,117910,117910,117910,117910,117910,117980,117980
.long 117910,117910,117980,117980,117980,117908,117908,117908,117908,117908,117978,117978
.long 117908,117908,117978,117978,117978,117906,117906,117906,117906,117906,117976,117976
.long 117906,117906,117976,117976,117976,117904,117904,117904,117904,117904,117974,117974
.long 117904,117904,117974,117974,117974,117902,117902,117902,117902,117902,117972,117972
.long 117902,117902,117972,117972,117972,117900,117900,117900,117900,117900,117970,117970
.long 117900,117900,117970,117970,117970,117898,117898,117898,117898,117898,117968,117968
.long 117898,117898,117968,117968,117968,117896,117896,117896,117896,117896,117966,117966
.long 117896,117896,117966,117966,117966,117894,117894,117894,117894,117894,117964,117964
.long 117894,117894,117964,117964,117964,117892,117892,117892,117892,117892,117962,117962
.long 117892,117892,117962,117962,117962,117890,117890,117890,117890,117890,117960,117960
.long 117890,117890,117960,117960,117960,117888,117888,117888,117888,117888,117958,117958
.long 117888,117888,117958,117958,117958,117886,117886,117886,117886,117886,117956,117956
.long 117886,117886,117956,117956,117956,117884,117884,117884,117884,117884,117954,117954
.long 117884,117884,117954,117954,117954,117882,117882,117882,117882,117882,117952,117952
.long 117882,117882,117952,117952,117952,117880,117880,117880,117880,117880,117950,117950
.long 117880,117880,117950,117950,117950,117878,117878,117878,117878,117878,117948,117948
.long 117878,117878,117948,117948,117948,117876,117876,117876,117876,117876,117946,117946
.long 117876,117876,117946,117946,117946,117874,117874,117874,117874,117874,117944,117944
.long 117874,117874,117944,117944,117944,117872,117872,117872,117872,117872,117862,117862
.long 117872,117872,117862,117862,117862,117790,117790,117790,117790,117790,117860,117860
.long 117790,117790,117860,117860,117860,117788,117788,117788,117788,117788,117858,117858
.long 117788,117788,117858,117858,117858,117786,117786,117786,117786,117786,117856,117856
.long 117786,117786,117856,117856,117856,117784,117784,117784,117784,117784,117854,117854
.long 117784,117784,117854,117854,117854,117782,117782,117782,117782,117782,117852,117852
.long 117782,117782,117852,117852,117852,117780,117780,117780,117780,117780,117850,117850
.long 117780,117780,117850,117850,117850,117778,117778,117778,117778,117778,117848,117848
.long 117778,117778,117848,117848,117848,117776,117776,117776,117776,117776,117846,117846
.long 117776,117776,117846,117846,117846,117774,117774,117774,117774,117774,117844,117844
.long 117774,117774,117844,117844,117844,117772,117772,117772,117772,117772,117842,117842
.long 117772,117772,117842,117842,117842,117770,117770,117770,117770,117770,117840,117840
.long 117770,117770,117840,117840,117840,117768,117768,117768,117768,117768,117838,117838
.long 117768,117768,117838,117838,117838,117766,117766,117766,117766,117766,117836,117836
.long 117766,117766,117836,117836,117836,117764,117764,117764,117764,117764,117834,117834
.long 117764,117764,117834,117834,117834,117762,117762,117762,117762,117762,117832,117832
.long 117762,117762,117832,117832,117832,117760,117760,117760,117760,117760,117830,117830
.long 117760,117760,117830,117830,117830,117758,117758,117758,117758,117758,117828,117828
.long 117758,117758,117828,117828,117828,117756,117756,117756,117756,117756,117826,117826
.long 117756,117756,117826,117826,117826,117754,117754,117754,117754,117754,117824,117824
.long 117754,117754,117824,117824,117824,117752,117752,117752,117752,117752,117822,117822
.long 117752,117752,117822,117822,117822,117750,117750,117750,117750,117750,117820,117820
.long 117750,117750,117820,117820,117820,117748,117748,117748,117748,117748,117818,117818
.long 117748,117748,117818,117818,117818,117746,117746,117746,117746,117746,117816,117816
.long 117746,117746,117816,117816,117816,117744,117744,117744,117744,117744,117814,117814
.long 117744,117744,117814,117814,117814,117742,117742,117742,117742,117742,117812,117812
.long 117742,117742,117812,117812,117812,117740,117740,117740,117740,117740,117810,117810
.long 117740,117740,117810,117810,117810,117738,117738,117738,117738,117738,117808,117808
.long 117738,117738,117808,117808,117808,117736,117736,117736,117736,117736,117806,117806
.long 117736,117736,117806,117806,117806,117734,117734,117734,117734,117734,117804,117804
.long 117734,117734,117804,117804,117804,117732,117732,117732,117732,117732,117802,117802
.long 117732,117732,117802,117802,117802,117730,117730,117730,117730,117730,117800,117800
.long 117730,117730,117800,117800,117800,117728,117728,117728,117728,117718,117646,117646
.long 117728,117718,117646,117646,117646,117574,117502,117502,117502,117716,117644,117644
.long 117502,117716,117644,117644,117644,117572,117500,117500,117500,117714,117642,117642
.long 117500,117714,117642,117642,117642,117570,117498,117498,117498,117712,117640,117640
.long 117498,117712,117640,117640,117640,117568,117496,117496,117496,117710,117638,117638
.long 117496,117710,117638,117638,117638,117566,117494,117494,117494,117708,117636,117636
.long 117494,117708,117636,117636,117636,117564,117492,117492,117492,117706,117634,117634
.long 117492,117706,117634,117634,117634,117562,117490,117490,117490,117704,117632,117632
.long 117490,117704,117632,117632,117632,117560,117488,117488,117488,117702,117630,117630
.long 117488,117702,117630,117630,117630,117558,117486,117486,117486,117700,117628,117628
.long 117486,117700,117628,117628,117628,117556,117484,117484,117484,117698,117626,117626
.long 117484,117698,117626,117626,117626,117554,117482,117482,117482,117696,117624,117624
.long 117482,117696,117624,117624,117624,117552,117480,117480,117480,117694,117622,117622
.long 117480,117694,117622,117622,117622,117550,117478,117478,117478,117692,117620,117620
.long 117478,117692,117620,117620,117620,117548,117476,117476,117476,117690,117618,117618
.long 117476,117690,117618,117618,117618,117546,117474,117474,117474,117688,117616,117616
.long 117474,117688,117616,117616,117616,117544,117472,117472,117472,117686,117614,117614
.long 117472,117686,117614,117614,117614,117542,117470,117470,117470,117684,117612,117612
.long 117470,117684,117612,117612,117612,117540,117468,117468,117468,117682,117610,117610
.long 117468,117682,117610,117610,117610,117538,117466,117466,117466,117680,117608,117608
.long 117466,117680,117608,117608,117608,117536,117464,117464,117464,117678,117606,117606
.long 117464,117678,117606,117606,117606,117534,117462,117462,117462,117676,117604,117604
.long 117462,117676,117604,117604,117604,117532,117460,117460,117460,117674,117602,117602
.long 117460,117674,117602,117602,117602,117530,117458,117458,117458,117672,117600,117600
.long 117458,117672,117600,117600,117600,117528,117456,117456,117456,117670,117598,117598
.long 117456,117670,117598,117598,117598,117526,117454,117454,117454,117668,117596,117596
.long 117454,117668,117596,117596,117596,117524,117452,117452,117452,117666,117594,117594
.long 117452,117666,117594,117594,117594,117522,117450,117450,117450,117664,117592,117592
.long 117450,117664,117592,117592,117592,117520,117448,117448,117448,117662,117590,117590
.long 117448,117662,117590,117590,117590,117518,117446,117446,117446,117660,117588,117588
.long 117446,117660,117588,117588,117588,117516,117444,117444,117444,117658,117586,117586
.long 117444,117658,117586,117586,117586,117514,117442,117442,117442,117656,117584,117584
.long 117442,117656,117584,117584,117584,117512,117440,117440,117430,117358,117286,117214
.long 117430,117358,117286,117214,117142,117070,116998,116926,117428,117356,117284,117212
.long 117428,117356,117284,117212,117140,117068,116996,116924,117426,117354,117282,117210
.long 117426,117354,117282,117210,117138,117066,116994,116922,117424,117352,117280,117208
.long 117424,117352,117280,117208,117136,117064,116992,116920,117422,117350,117278,117206
.long 117422,117350,117278,117206,117134,117062,116990,116918,117420,117348,117276,117204
.long 117420,117348,117276,117204,117132,117060,116988,116916,117418,117346,117274,117202
.long 117418,117346,117274,117202,117130,117058,116986,116914,117416,117344,117272,117200
.long 117416,117344,117272,117200,117128,117056,116984,116912,117414,117342,117270,117198
.long 117414,117342,117270,117198,117126,117054,116982,116910,117412,117340,117268,117196
.long 117412,117340,117268,117196,117124,117052,116980,116908,117410,117338,117266,117194
.long 117410,117338,117266,117194,117122,117050,116978,116906,117408,117336,117264,117192
.long 117408,117336,117264,117192,117120,117048,116976,116904,117406,117334,117262,117190
.long 117406,117334,117262,117190,117118,117046,116974,116902,117404,117332,117260,117188
.long 117404,117332,117260,117188,117116,117044,116972,116900,117402,117330,117258,117186
.long 117402,117330,117258,117186,117114,117042,116970,116898,117400,117328,117256,117184
.long 117400,117328,117256,117184,117112,117040,116968,116896,117398,117326,117254,117182
.long 117398,117326,117254,117182,117110,117038,116966,116894,117396,117324,117252,117180
.long 117396,117324,117252,117180,117108,117036,116964,116892,117394,117322,117250,117178
.long 117394,117322,117250,117178,117106,117034,116962,116890,117392,117320,117248,117176
.long 117392,117320,117248,117176,117104,117032,116960,116888,117390,117318,117246,117174
.long 117390,117318,117246,117174,117102,117030,116958,116886,117388,117316,117244,117172
.long 117388,117316,117244,117172,117100,117028,116956,116884,117386,117314,117242,117170
.long 117386,117314,117242,117170,117098,117026,116954,116882,117384,117312,117240,117168
.long 117384,117312,117240,117168,117096,117024,116952,116880,117382,117310,117238,117166
.long 117382,117310,117238,117166,117094,117022,116950,116878,117380,117308,117236,117164
.long 117380,117308,117236,117164,117092,117020,116948,116876,117378,117306,117234,117162
.long 117378,117306,117234,117162,117090,117018,116946,116874,117376,117304,117232,117160
.long 117376,117304,117232,117160,117088,117016,116944,116872,117374,117302,117230,117158
.long 117374,117302,117230,117158,117086,117014,116942,116870,117372,117300,117228,117156
.long 117372,117300,117228,117156,117084,117012,116940,116868,117370,117298,117226,117154
.long 117370,117298,117226,117154,117082,117010,116938,116866,117368,117296,117224,117152
.long 117368,117296,117224,117152,117080,117008,116936,116864,118376,118376,118376,118376
.size T1_table, 24576
.p2align 6
.amdhsa_kernel recurrent_scan__ssm_conv_s4d__moe_arch_mod__prompt_kernel
  .amdhsa_next_free_vgpr 256
  .amdhsa_next_free_sgpr 102
  .amdhsa_accum_offset 128
  .amdhsa_group_segment_fixed_size 0
  .amdhsa_kernarg_size 120
  .amdhsa_user_sgpr_count 2
  .amdhsa_user_sgpr_kernarg_segment_ptr 1
  .amdhsa_system_sgpr_workgroup_id_x 1
  .amdhsa_float_denorm_mode_32 3
.end_amdhsa_kernel
```
